```python
import torch

def _softmax(x, axis=-1):
    return torch.softmax(x, dim=axis)
def _gelu(x):
    return torch.nn.functional.gelu(x, approximate="tanh")
def _silu(x):
    return torch.nn.functional.silu(x)
def _sigmoid(x):
    return torch.sigmoid(x)
def _layernorm(x, axis=-1, eps=1e-5):
    m = x.mean(dim=axis, keepdim=True)
    v = x.var(dim=axis, keepdim=True, unbiased=False)
    return (x - m) / torch.sqrt(v + eps)
def _scatter_add(tgt, idx, src, axis=0):
    return tgt.clone().index_add_(axis, idx, src)
def _segment_sum(src, seg, n):
    out = torch.zeros((n,) + src.shape[1:], dtype=src.dtype)
    return out.index_add_(0, seg, src)
def _pad(x, pw):
    flat = tuple(v for pair in reversed(pw) for v in pair)
    return torch.nn.functional.pad(x, flat)

kernel_name = 'sequential_preLN__ssm_conv_h3__dense_activation_squared_relu__prompt'

def setup_inputs():

    _w = (lambda a: (lambda t: t.to(torch.bfloat16) if t.is_floating_point() else t)(torch.as_tensor(a)))
    def _A_setup():
        B, S, D = 1, 2048, 1024
        ks = 4
        return {
            "q": _w((lambda *s: torch.randn(*s, dtype=torch.bfloat16) * 0.05)(B, S, D)),
            "k": _w((lambda *s: torch.randn(*s, dtype=torch.bfloat16) * 0.4)(B, S, D)),
            "v": _w((lambda *s: torch.randn(*s, dtype=torch.bfloat16) * 0.4)(B, S, D)),
            "shift_k": _w((lambda *s: torch.randn(*s, dtype=torch.bfloat16) * 0.4)(D, ks) * 0.5),
            "ssm_k": _w((lambda *s: torch.randn(*s, dtype=torch.bfloat16) * 0.4)(D, S) * (1.0 / S ** 0.5)),
            "ssm_D": _w((lambda *s: torch.randn(*s, dtype=torch.bfloat16) * 0.4)(D)),
        }
    _A_in = _A_setup()

    def _B_setup():
        B, S, D, F = 1, 2048, 1024, 3584
        return {
            "x": _w((lambda *s: torch.randn(*s, dtype=torch.bfloat16) * 0.05)(B, S, D)),
            "w1": _w((lambda *s: torch.randn(*s, dtype=torch.bfloat16) * 0.05)(D, F)),
            "b1": _w((lambda *s: torch.randn(*s, dtype=torch.bfloat16) * 0.4)(F)),
            "w2": _w((lambda *s: torch.randn(*s, dtype=torch.bfloat16) * 0.05)(F, D)),
            "b2": _w((lambda *s: torch.randn(*s, dtype=torch.bfloat16) * 3.2)(D)),
        }
    _B_in = _B_setup()

    return {
        "A_q": _A_in["q"],
        "A_k": _A_in["k"],
        "A_v": _A_in["v"],
        "A_shift_k": _A_in["shift_k"],
        "A_ssm_k": _A_in["ssm_k"],
        "A_ssm_D": _A_in["ssm_D"],
        "B_x": _B_in["x"],
        "B_w1": _B_in["w1"],
        "B_b1": _B_in["b1"],
        "B_w2": _B_in["w2"],
        "B_b2": _B_in["b2"],
    }

def reference(A_q, A_k, A_v, A_shift_k, A_ssm_k, A_ssm_D, B_x, B_w1, B_b1, B_w2, B_b2):
    def _A_ref(q, k, v, shift_k, ssm_k, ssm_D):
        B, S, D = q.shape
        ks = shift_k.shape[-1]
        k_pad = _pad(k, ((0, 0), (ks - 1, 0), (0, 0)))
        k_shift = torch.zeros_like(k)
        for t in range(ks):
            k_shift = k_shift + k_pad[:, t:t + S, :] * shift_k[:, ks - 1 - t][None, None, :]
        kv = k_shift * v
        L = 2 * S
        kv_pad = _pad(kv, ((0, 0), (0, S), (0, 0)))
        kf_pad = _pad(ssm_k, ((0, 0), (0, S)))
        kv_f = (lambda x, axes=(-2,-1): torch.fft.rfft2(x.float(), dim=axes))(kv_pad[:, None, :, :], axes=(1, 2))
        kf_f = (lambda x, axes=(-2,-1): torch.fft.rfft2(x.float(), dim=axes))(kf_pad[:, None, :], axes=(1, 2))
        kf_f = (lambda x, *d: x.permute(*d))(kf_f, 1, 2, 0)
        y_f = kv_f * kf_f[None, :, :, :]
        y = (lambda x, s, axes=(-2,-1): torch.fft.irfft2(x, s=s, dim=axes).to(torch.bfloat16))(y_f, (1, L), axes=(1, 2))[:, 0, :S, :]
        y = y + kv * ssm_D[None, None, :]
        return q * y

    def _B_ref(x, w1, b1, w2, b2):
        h = torch.einsum("bsd,df->bsf", x, w1) + b1
        zero = torch.zeros_like(h)
        r = torch.where(h > zero, h, zero)
        h = r * r
        out = torch.einsum("bsf,fd->bsd", h, w2) + b2
        return out

    x = A_q
    h = x + _A_ref(_layernorm(x, axis=-1), A_k, A_v, A_shift_k, A_ssm_k, A_ssm_D)
    h2 = h + _B_ref(_layernorm(h, axis=-1), B_w1, B_b1, B_w2, B_b2)
    return h2
```

```asm
; @launch grid=(256,1,1) block=(512,1,1) lds=163840
.amdgcn_target "amdgcn-amd-amdhsa--gfx950"
.text
.globl sequential_preLN__ssm_conv_h3__dense_activation_squared_relu__prompt_kernel
.p2align 8
.type sequential_preLN__ssm_conv_h3__dense_activation_squared_relu__prompt_kernel,@function
sequential_preLN__ssm_conv_h3__dense_activation_squared_relu__prompt_kernel:
    s_load_dwordx4 s[4:7], s[0:1], 8
    s_load_dwordx4 s[56:59], s[0:1], 96
    s_load_dwordx2 s[42:43], s[0:1], 0
    s_cmp_ge_u32 s2, 256
    s_cbranch_scc1 F_end
    v_readfirstlane_b32 s33, v0
    s_and_b32 s24, s2, 7
    s_lshr_b32 s25, s2, 3
    v_bfe_u32 v5, v0, 4, 4
    v_and_b32 v6, 15, v0
    v_lshlrev_b32 v5, 11, v5
    v_lshl_add_u32 v5, v6, 4, v5
    s_lshl_b32 s62, s24, 5
    s_add_u32 s62, s62, s25
    v_lshrrev_b32 v4, 3, v0
    v_and_b32 v3, 7, v0
    v_lshlrev_b32 v16, 15, v4
    v_lshl_add_u32 v16, v3, 4, v16
    s_lshl_b32 s27, s62, 7
    s_add_u32 s27, s27, 0xcc0000
    v_add_u32 v16, s27, v16
    v_mov_b64 v[12:13], 0
    v_mov_b64 v[14:15], 0
    s_lshr_b32 s33, s33, 6
    s_and_b32 s34, s33, 3
    s_lshl_b32 s26, s25, 17
    s_lshl_b32 s27, s24, 8
    s_add_u32 s26, s26, s27
    s_mul_i32 s35, s34, 1040
    s_mov_b32 s14, 0x400000
    s_mov_b32 s15, 0x00020000
    s_mov_b32 s44, 0x8000
    v_cmp_gt_u32 vcc, 40, v0
    s_cmp_ge_u32 s33, 4
    s_cselect_b32 s27, 102672, s44
    s_cselect_b32 s28, 0, 53264
    s_add_u32 s27, s27, s28
    s_add_u32 m0, s35, s27
    s_cmp_ge_u32 s33, 4
    s_waitcnt lgkmcnt(0)
    s_cselect_b64 s[12:13], s[6:7], s[4:5]
    s_and_saveexec_b64 s[30:31], vcc
    s_cbranch_execz F_nocl
    global_store_dwordx4 v16, v[12:15], s[58:59] sc1
F_nocl:
    s_mov_b64 exec, s[30:31]
    s_mov_b32 s27, s26
    buffer_load_dwordx4 v5, s[12:15], s27 offen nt lds
    s_add_u32 m0, m0, 4160
    s_add_u32 s27, s27, s44
    buffer_load_dwordx4 v5, s[12:15], s27 offen nt lds
    s_add_u32 m0, m0, 4160
    s_add_u32 s27, s27, s44
    buffer_load_dwordx4 v5, s[12:15], s27 offen nt lds
    s_add_u32 m0, m0, 4160
    s_add_u32 s27, s27, s44
    buffer_load_dwordx4 v5, s[12:15], s27 offen nt lds
    s_load_dwordx4 s[8:11], s[0:1], 24
    s_load_dwordx2 s[60:61], s[0:1], 40
    v_and_b32 v2, 63, v0
    v_and_b32 v4, 7, v4
    s_lshl_b32 s62, s62, 2
    s_add_u32 s63, s62, s34
    s_mul_i32 s64, s34, 21248
    s_cmp_ge_u32 s33, 4
    s_cbranch_scc1 F_help
    v_and_b32 v6, 0x1fff, v5
    v_add_u32 v6, s26, v6
    v_subrev_u32 v6, 8192, v6
    s_mov_b32 m0, 84992
    s_nop 0
    buffer_load_dwordx4 v6, s[12:15], 0 offen nt lds
    s_waitcnt lgkmcnt(0)
    s_mov_b32 s20, s8
    s_mov_b32 s21, s9
    s_mov_b32 s22, 0x2000
    s_mov_b32 s23, 0x00020000
    s_lshl_b32 s27, s24, 10
    s_lshl_b32 s28, s34, 8
    s_add_u32 s27, s27, s28
    v_lshlrev_b32 v8, 5, v4
    buffer_load_dwordx4 v[56:59], v8, s[20:23], s27 offen
    buffer_load_dwordx4 v[60:63], v8, s[20:23], s27 offen offset:16
    s_lshr_b32 s28, s63, 1
    s_lshl_b32 s28, s28, 2
    s_load_dword s29, s[60:61], s28
    v_mul_u32_u24 v7, 2080, v3
    v_lshl_add_u32 v7, v4, 3, v7
    s_lshl_b32 s27, s34, 6
    s_add_u32 s27, s27, 84992
    v_add_u32 v7, s27, v7
    v_mov_b32 v10, 152448
    v_mov_b32 v16, 0
    v_mov_b32 v17, 0
    v_mov_b32 v18, 0
    v_mov_b32 v19, 0
    ds_write_b128 v10, v[16:19]
    ds_write_b128 v10, v[16:19] offset:16
    ds_write_b128 v10, v[16:19] offset:32
    ds_write_b128 v10, v[16:19] offset:48
    s_add_u32 s49, s64, 16640
    s_mov_b32 s36, s58
    s_mov_b32 s37, s59
    s_mov_b32 s38, 0x4000000
    s_mov_b32 s39, 0x00020000
    s_mov_b32 s52, s56
    s_mov_b32 s53, s57
    s_mov_b32 s54, 0x100
    s_mov_b32 s55, 0x00020000
    v_lshlrev_b32 v39, 5, v3
    v_xor_b32 v13, 7, v3
    v_lshlrev_b32 v13, 4, v13
    v_lshl_add_u32 v13, v4, 14, v13
    s_lshl_b32 s47, s24, 19
    s_lshl_b32 s48, s34, 17
    s_add_u32 s47, s47, s48
    s_lshl_b32 s48, s25, 7
    s_sub_u32 s48, 3968, s48
    s_add_u32 s47, s47, s48
    s_waitcnt lgkmcnt(0)
    s_barrier
    s_cmp_lg_u32 s33, 0
    s_cbranch_scc1 F_noreg
    s_getreg_b32 s65, hwreg(HW_REG_XCC_ID)
    s_and_b32 s65, s65, 7
    s_lshl_b32 s65, s65, 3
    s_lshl_b64 s[66:67], 1, s65
    v_mov_b32 v16, s66
    v_mov_b32 v17, s67
    v_mov_b32 v12, 0
    s_lshl_b32 s30, s24, 5
    s_mov_b64 exec, 1
    s_waitcnt vmcnt(7)
    buffer_atomic_add_x2 v[16:17], v12, s[52:55], s30 offen sc1
    v_mov_b32 v11, 1
    ds_write_b32 v10, v11 offset:44
    s_mov_b64 exec, -1
    s_waitcnt vmcnt(1)
    s_branch F_kvl
F_noreg:
    s_waitcnt vmcnt(0)
F_kvl:
    s_nop 0
    v_mov_b32 v11, 1
    s_mov_b64 exec, 1
    ds_add_u32 v10, v11 offset:32
    s_mov_b64 exec, -1
F_spk:
    ds_read_b32 v12, v10 offset:32
    s_waitcnt lgkmcnt(0)
    v_readfirstlane_b32 s35, v12
    s_cmp_eq_u32 s35, 8
    s_cbranch_scc1 F_sqk
    s_sleep 1
    s_branch F_spk
F_sqk:
    ds_read_b64 v[208:209], v7 offset:256
    ds_read_b64 v[210:211], v7 offset:512
    ds_read_b64 v[212:213], v7 offset:768
    ds_read_b64 v[214:215], v7 offset:1040
    ds_read_b64 v[40:41], v7 offset:17680
    ds_read_b64 v[216:217], v7 offset:1296
    ds_read_b64 v[42:43], v7 offset:17936
    ds_read_b64 v[218:219], v7 offset:1552
    ds_read_b64 v[44:45], v7 offset:18192
    ds_read_b64 v[220:221], v7 offset:1808
    ds_read_b64 v[46:47], v7 offset:18448
    ds_read_b64 v[222:223], v7 offset:2080
    ds_read_b64 v[48:49], v7 offset:18720
    v_lshlrev_b32 v64, 16, v56
    v_and_b32 v66, 0xffff0000, v56
    v_lshlrev_b32 v68, 16, v57
    v_and_b32 v70, 0xffff0000, v57
    v_lshlrev_b32 v65, 16, v58
    v_and_b32 v67, 0xffff0000, v58
    v_lshlrev_b32 v69, 16, v59
    v_and_b32 v71, 0xffff0000, v59
    v_lshlrev_b32 v72, 16, v60
    v_and_b32 v74, 0xffff0000, v60
    v_lshlrev_b32 v76, 16, v61
    v_and_b32 v78, 0xffff0000, v61
    v_lshlrev_b32 v73, 16, v62
    v_and_b32 v75, 0xffff0000, v62
    v_lshlrev_b32 v77, 16, v63
    v_and_b32 v79, 0xffff0000, v63
    s_waitcnt lgkmcnt(8)
    ds_read_b64 v[224:225], v7 offset:2336
    ds_read_b64 v[50:51], v7 offset:18976
    ds_read_b64 v[226:227], v7 offset:2592
    ds_read_b64 v[52:53], v7 offset:19232
    ds_read_b64 v[228:229], v7 offset:2848
    ds_read_b64 v[54:55], v7 offset:19488
    v_lshlrev_b32 v80, 16, v208
    v_and_b32 v81, 0xffff0000, v208
    v_lshlrev_b32 v82, 16, v209
    v_and_b32 v83, 0xffff0000, v209
    v_lshlrev_b32 v84, 16, v210
    v_and_b32 v85, 0xffff0000, v210
    v_lshlrev_b32 v86, 16, v211
    v_and_b32 v87, 0xffff0000, v211
    v_lshlrev_b32 v88, 16, v212
    v_and_b32 v89, 0xffff0000, v212
    v_lshlrev_b32 v90, 16, v213
    v_and_b32 v91, 0xffff0000, v213
    v_lshlrev_b32 v92, 16, v214
    v_and_b32 v93, 0xffff0000, v214
    v_lshlrev_b32 v94, 16, v215
    v_and_b32 v95, 0xffff0000, v215
    v_lshlrev_b32 v124, 16, v40
    v_and_b32 v125, 0xffff0000, v40
    v_lshlrev_b32 v126, 16, v41
    v_and_b32 v127, 0xffff0000, v41
    v_pk_mul_f32 v[156:157], v[80:81], v[70:71]
    v_pk_fma_f32 v[156:157], v[84:85], v[68:69], v[156:157]
    v_pk_fma_f32 v[156:157], v[88:89], v[66:67], v[156:157]
    v_pk_fma_f32 v[156:157], v[92:93], v[64:65], v[156:157]
    v_pk_mul_f32 v[156:157], v[156:157], v[124:125]
    v_pk_mul_f32 v[158:159], v[82:83], v[78:79]
    v_pk_fma_f32 v[158:159], v[86:87], v[76:77], v[158:159]
    v_pk_fma_f32 v[158:159], v[90:91], v[74:75], v[158:159]
    v_pk_fma_f32 v[158:159], v[94:95], v[72:73], v[158:159]
    v_pk_mul_f32 v[158:159], v[158:159], v[126:127]
    s_waitcnt lgkmcnt(12)
    v_lshlrev_b32 v96, 16, v216
    v_and_b32 v97, 0xffff0000, v216
    v_lshlrev_b32 v98, 16, v217
    v_and_b32 v99, 0xffff0000, v217
    v_lshlrev_b32 v128, 16, v42
    v_and_b32 v129, 0xffff0000, v42
    v_lshlrev_b32 v130, 16, v43
    v_and_b32 v131, 0xffff0000, v43
    v_pk_mul_f32 v[160:161], v[84:85], v[70:71]
    v_pk_fma_f32 v[160:161], v[88:89], v[68:69], v[160:161]
    v_pk_fma_f32 v[160:161], v[92:93], v[66:67], v[160:161]
    v_pk_fma_f32 v[160:161], v[96:97], v[64:65], v[160:161]
    v_pk_mul_f32 v[160:161], v[160:161], v[128:129]
    v_pk_mul_f32 v[162:163], v[86:87], v[78:79]
    v_pk_fma_f32 v[162:163], v[90:91], v[76:77], v[162:163]
    v_pk_fma_f32 v[162:163], v[94:95], v[74:75], v[162:163]
    v_pk_fma_f32 v[162:163], v[98:99], v[72:73], v[162:163]
    v_pk_mul_f32 v[162:163], v[162:163], v[130:131]
    s_waitcnt lgkmcnt(10)
    v_lshlrev_b32 v100, 16, v218
    v_and_b32 v101, 0xffff0000, v218
    v_lshlrev_b32 v102, 16, v219
    v_and_b32 v103, 0xffff0000, v219
    v_lshlrev_b32 v132, 16, v44
    v_and_b32 v133, 0xffff0000, v44
    v_lshlrev_b32 v134, 16, v45
    v_and_b32 v135, 0xffff0000, v45
    v_pk_mul_f32 v[164:165], v[88:89], v[70:71]
    v_pk_fma_f32 v[164:165], v[92:93], v[68:69], v[164:165]
    v_pk_fma_f32 v[164:165], v[96:97], v[66:67], v[164:165]
    v_pk_fma_f32 v[164:165], v[100:101], v[64:65], v[164:165]
    v_pk_mul_f32 v[164:165], v[164:165], v[132:133]
    v_pk_mul_f32 v[166:167], v[90:91], v[78:79]
    v_pk_fma_f32 v[166:167], v[94:95], v[76:77], v[166:167]
    v_pk_fma_f32 v[166:167], v[98:99], v[74:75], v[166:167]
    v_pk_fma_f32 v[166:167], v[102:103], v[72:73], v[166:167]
    v_pk_mul_f32 v[166:167], v[166:167], v[134:135]
    s_waitcnt lgkmcnt(8)
    v_lshlrev_b32 v104, 16, v220
    v_and_b32 v105, 0xffff0000, v220
    v_lshlrev_b32 v106, 16, v221
    v_and_b32 v107, 0xffff0000, v221
    v_lshlrev_b32 v136, 16, v46
    v_and_b32 v137, 0xffff0000, v46
    v_lshlrev_b32 v138, 16, v47
    v_and_b32 v139, 0xffff0000, v47
    v_pk_mul_f32 v[168:169], v[92:93], v[70:71]
    v_pk_fma_f32 v[168:169], v[96:97], v[68:69], v[168:169]
    v_pk_fma_f32 v[168:169], v[100:101], v[66:67], v[168:169]
    v_pk_fma_f32 v[168:169], v[104:105], v[64:65], v[168:169]
    v_pk_mul_f32 v[168:169], v[168:169], v[136:137]
    v_pk_mul_f32 v[170:171], v[94:95], v[78:79]
    v_pk_fma_f32 v[170:171], v[98:99], v[76:77], v[170:171]
    v_pk_fma_f32 v[170:171], v[102:103], v[74:75], v[170:171]
    v_pk_fma_f32 v[170:171], v[106:107], v[72:73], v[170:171]
    v_pk_mul_f32 v[170:171], v[170:171], v[138:139]
    s_waitcnt lgkmcnt(6)
    v_lshlrev_b32 v108, 16, v222
    v_and_b32 v109, 0xffff0000, v222
    v_lshlrev_b32 v110, 16, v223
    v_and_b32 v111, 0xffff0000, v223
    v_lshlrev_b32 v140, 16, v48
    v_and_b32 v141, 0xffff0000, v48
    v_lshlrev_b32 v142, 16, v49
    v_and_b32 v143, 0xffff0000, v49
    v_pk_mul_f32 v[172:173], v[96:97], v[70:71]
    v_pk_fma_f32 v[172:173], v[100:101], v[68:69], v[172:173]
    v_pk_fma_f32 v[172:173], v[104:105], v[66:67], v[172:173]
    v_pk_fma_f32 v[172:173], v[108:109], v[64:65], v[172:173]
    v_pk_mul_f32 v[172:173], v[172:173], v[140:141]
    v_pk_mul_f32 v[174:175], v[98:99], v[78:79]
    v_pk_fma_f32 v[174:175], v[102:103], v[76:77], v[174:175]
    v_pk_fma_f32 v[174:175], v[106:107], v[74:75], v[174:175]
    v_pk_fma_f32 v[174:175], v[110:111], v[72:73], v[174:175]
    v_pk_mul_f32 v[174:175], v[174:175], v[142:143]
    s_waitcnt lgkmcnt(4)
    v_lshlrev_b32 v112, 16, v224
    v_and_b32 v113, 0xffff0000, v224
    v_lshlrev_b32 v114, 16, v225
    v_and_b32 v115, 0xffff0000, v225
    v_lshlrev_b32 v144, 16, v50
    v_and_b32 v145, 0xffff0000, v50
    v_lshlrev_b32 v146, 16, v51
    v_and_b32 v147, 0xffff0000, v51
    v_pk_mul_f32 v[176:177], v[100:101], v[70:71]
    v_pk_fma_f32 v[176:177], v[104:105], v[68:69], v[176:177]
    v_pk_fma_f32 v[176:177], v[108:109], v[66:67], v[176:177]
    v_pk_fma_f32 v[176:177], v[112:113], v[64:65], v[176:177]
    v_pk_mul_f32 v[176:177], v[176:177], v[144:145]
    v_pk_mul_f32 v[178:179], v[102:103], v[78:79]
    v_pk_fma_f32 v[178:179], v[106:107], v[76:77], v[178:179]
    v_pk_fma_f32 v[178:179], v[110:111], v[74:75], v[178:179]
    v_pk_fma_f32 v[178:179], v[114:115], v[72:73], v[178:179]
    v_pk_mul_f32 v[178:179], v[178:179], v[146:147]
    s_waitcnt lgkmcnt(2)
    v_lshlrev_b32 v116, 16, v226
    v_and_b32 v117, 0xffff0000, v226
    v_lshlrev_b32 v118, 16, v227
    v_and_b32 v119, 0xffff0000, v227
    v_lshlrev_b32 v148, 16, v52
    v_and_b32 v149, 0xffff0000, v52
    v_lshlrev_b32 v150, 16, v53
    v_and_b32 v151, 0xffff0000, v53
    v_pk_mul_f32 v[180:181], v[104:105], v[70:71]
    v_pk_fma_f32 v[180:181], v[108:109], v[68:69], v[180:181]
    v_pk_fma_f32 v[180:181], v[112:113], v[66:67], v[180:181]
    v_pk_fma_f32 v[180:181], v[116:117], v[64:65], v[180:181]
    v_pk_mul_f32 v[180:181], v[180:181], v[148:149]
    v_pk_mul_f32 v[182:183], v[106:107], v[78:79]
    v_pk_fma_f32 v[182:183], v[110:111], v[76:77], v[182:183]
    v_pk_fma_f32 v[182:183], v[114:115], v[74:75], v[182:183]
    v_pk_fma_f32 v[182:183], v[118:119], v[72:73], v[182:183]
    v_pk_mul_f32 v[182:183], v[182:183], v[150:151]
    s_waitcnt lgkmcnt(0)
    v_lshlrev_b32 v120, 16, v228
    v_and_b32 v121, 0xffff0000, v228
    v_lshlrev_b32 v122, 16, v229
    v_and_b32 v123, 0xffff0000, v229
    v_lshlrev_b32 v152, 16, v54
    v_and_b32 v153, 0xffff0000, v54
    v_lshlrev_b32 v154, 16, v55
    v_and_b32 v155, 0xffff0000, v55
    v_pk_mul_f32 v[184:185], v[108:109], v[70:71]
    v_pk_fma_f32 v[184:185], v[112:113], v[68:69], v[184:185]
    v_pk_fma_f32 v[184:185], v[116:117], v[66:67], v[184:185]
    v_pk_fma_f32 v[184:185], v[120:121], v[64:65], v[184:185]
    v_pk_mul_f32 v[184:185], v[184:185], v[152:153]
    v_pk_mul_f32 v[186:187], v[110:111], v[78:79]
    v_pk_fma_f32 v[186:187], v[114:115], v[76:77], v[186:187]
    v_pk_fma_f32 v[186:187], v[118:119], v[74:75], v[186:187]
    v_pk_fma_f32 v[186:187], v[122:123], v[72:73], v[186:187]
    v_pk_mul_f32 v[186:187], v[186:187], v[154:155]
    v_cvt_pk_bf16_f32 v190, v184, v180
    v_cvt_pk_bf16_f32 v191, v176, v172
    v_cvt_pk_bf16_f32 v192, v168, v164
    v_cvt_pk_bf16_f32 v193, v160, v156
    buffer_store_dwordx4 v[190:193], v13, s[36:39], s47 offen sc1
    s_add_u32 s47, s47, 4096
    v_cvt_pk_bf16_f32 v194, v185, v181
    v_cvt_pk_bf16_f32 v195, v177, v173
    v_cvt_pk_bf16_f32 v196, v169, v165
    v_cvt_pk_bf16_f32 v197, v161, v157
    buffer_store_dwordx4 v[194:197], v13, s[36:39], s47 offen sc1
    s_add_u32 s47, s47, 4096
    v_cvt_pk_bf16_f32 v198, v186, v182
    v_cvt_pk_bf16_f32 v199, v178, v174
    v_cvt_pk_bf16_f32 v200, v170, v166
    v_cvt_pk_bf16_f32 v201, v162, v158
    buffer_store_dwordx4 v[198:201], v13, s[36:39], s47 offen sc1
    s_add_u32 s47, s47, 4096
    v_cvt_pk_bf16_f32 v202, v187, v183
    v_cvt_pk_bf16_f32 v203, v179, v175
    v_cvt_pk_bf16_f32 v204, v171, v167
    v_cvt_pk_bf16_f32 v205, v163, v159
    buffer_store_dwordx4 v[202:205], v13, s[36:39], s47 offen sc1
    s_add_u32 s47, s47, 4096
    s_cmp_lg_u32 s33, 0
    s_cbranch_scc1 F_nr1
    buffer_load_dwordx2 v[36:37], v39, s[52:55], 0 offen sc1
F_nr1:
    v_lshlrev_b32 v40, 4, v2
    v_add_u32 v4, s64, v40
    v_mov_b32 v60, 0
    v_mov_b32 v61, 0
    v_mov_b32 v62, 0
    v_mov_b32 v63, 0
    s_mov_b64 exec, 0x3fffffff
    ds_write_b128 v4, v[60:63] offset:20736
    s_mov_b64 exec, -1
    v_and_b32 v5, 15, v2
    v_lshrrev_b32 v6, 4, v2
    v_add_u32 v7, 1, v5
    v_and_b32 v8, 3, v7
    v_mul_u32_u24 v8, 4160, v8
    v_and_b32 v7, 28, v7
    v_lshl_add_u32 v8, v7, 1, v8
    v_lshl_add_u32 v8, v6, 4, v8
    v_add_u32 v8, s64, v8
    v_lshlrev_b32 v9, 5, v5
    v_lshl_add_u32 v41, v6, 3, v9
    v_sub_u32 v9, 17120, v9
    v_lshl_add_u32 v9, v6, 4, v9
    v_add_u32 v9, s64, v9
    s_lshl_b32 s26, s63, 12
    s_add_u32 m0, s64, 16640
    v_mov_b64 v[80:81], 0
    v_mov_b64 v[82:83], 0
    v_mov_b64 v[84:85], 0
    v_mov_b64 v[86:87], 0
    v_mov_b64 v[88:89], 0
    v_mov_b64 v[90:91], 0
    v_mov_b64 v[92:93], 0
    v_mov_b64 v[94:95], 0
    v_mov_b64 v[96:97], 0
    v_mov_b64 v[98:99], 0
    v_mov_b64 v[100:101], 0
    v_mov_b64 v[102:103], 0
    v_mov_b64 v[104:105], 0
    v_mov_b64 v[106:107], 0
    v_mov_b64 v[108:109], 0
    v_mov_b64 v[110:111], 0
    v_sub_u32 v32, 17144, v41
    v_add_u32 v32, s64, v32
    v_lshlrev_b32 v33, 1, v41
    v_add_u32 v33, 135808, v33
    s_lshl_b32 s35, s34, 12
    s_add_u32 s35, s35, 119424
    v_add_u32 v34, s35, v41
    s_lshl_b32 s75, s29, 16
    s_and_b32 s27, s29, 0xffff0000
    s_bitcmp1_b32 s63, 0
    s_cselect_b32 s75, s27, s75
    s_and_b32 s27, s63, 3
    s_bfe_u32 s28, s63, 0x10003
    s_lshl_b32 s28, s28, 2
    s_or_b32 s27, s27, s28
    v_and_b32 v42, 7, v5
    v_xor_b32 v42, s27, v42
    v_lshlrev_b32 v42, 5, v42
    v_lshrrev_b32 v12, 3, v5
    v_lshl_add_u32 v42, v12, 18, v42
    v_and_b32 v12, 1, v6
    v_lshl_add_u32 v42, v12, 19, v42
    v_lshrrev_b32 v12, 1, v6
    v_lshl_add_u32 v42, v12, 4, v42
    s_lshl_b32 s34, s63, 8
    s_add_u32 s34, s34, 0x800000
    v_mov_b32 v12, 0
    s_waitcnt vmcnt(0)
    s_mov_b64 exec, 1
    ds_add_u32 v10, v11 offset:0
    s_mov_b64 exec, -1
    s_cmp_lg_u32 s33, 0
    s_cbranch_scc1 F_w1
    s_getreg_b32 s65, hwreg(HW_REG_XCC_ID)
    s_and_b32 s65, s65, 7
    s_lshl_b32 s65, s65, 3
    s_lshl_b64 s[66:67], 32, s65
F_rga:
    v_sad_u8 v38, v36, 0, 0
    v_sad_u8 v38, v37, 0, v38
    v_cmp_eq_u32 vcc, 32, v38
    s_cmp_eq_u64 vcc, -1
    s_cbranch_scc1 F_rka
    s_sleep 24
    buffer_load_dwordx2 v[36:37], v39, s[52:55], 0 offen sc1
    s_waitcnt vmcnt(0)
    s_branch F_rga
F_rka:
    v_readlane_b32 s68, v36, s24
    v_readlane_b32 s69, v37, s24
    s_cmp_eq_u64 s[68:69], s[66:67]
    s_cselect_b32 s65, 1, 0
    s_add_u32 s65, s65, 1
    v_mov_b32 v38, s65
    ds_write_b32 v10, v38 offset:28
    s_sub_u32 s65, s65, 1
F_spd:
    ds_read_b32 v13, v10 offset:0
    s_waitcnt lgkmcnt(0)
    v_readfirstlane_b32 s35, v13
    s_cmp_eq_u32 s35, 4
    s_cbranch_scc1 F_sqd
    s_sleep 1
    s_branch F_spd
F_sqd:
    s_lshl_b32 s27, s62, 5
    s_and_b32 s28, s27, 0xfffff000
    s_add_u32 s27, s27, 0xcc0000
    s_add_u32 s28, s28, 0xcc0000
    v_and_b32 v14, 31, v2
    v_lshlrev_b32 v14, 7, v14
    s_mov_b64 exec, 1
    s_cmp_eq_u32 s65, 1
    s_cbranch_scc1 F_sla
    buffer_store_dword v11, v12, s[36:39], s27 offen sc1
    s_branch F_ppa
F_sla:
    buffer_store_dword v11, v12, s[36:39], s27 offen
F_ppa:
    s_mov_b64 exec, -1
F_pla:
    buffer_load_dword v15, v14, s[36:39], s28 offen sc1
    s_waitcnt vmcnt(0)
    v_cmp_eq_u32 vcc, 1, v15
    s_cmp_eq_u64 vcc, -1
    s_cbranch_scc0 F_pla
    ds_write_b32 v10, v11 offset:4
    s_branch F_g1
F_w1:
F_spa:
    ds_read_b32 v13, v10 offset:4
    s_waitcnt lgkmcnt(0)
    v_readfirstlane_b32 s35, v13
    s_cmp_eq_u32 s35, 1
    s_cbranch_scc1 F_sqa
    s_sleep 1
    s_branch F_spa
F_sqa:
F_g1:
    buffer_load_dwordx4 v40, s[36:39], s26 offen offset:0 sc1 lds
    buffer_load_dwordx4 v40, s[36:39], s26 offen offset:1024 sc1 lds
    buffer_load_dwordx4 v40, s[36:39], s26 offen offset:2048 sc1 lds
    buffer_load_dwordx4 v40, s[36:39], s26 offen offset:3072 sc1 lds
F_spb:
    ds_read_b32 v13, v10 offset:8
    s_waitcnt lgkmcnt(0)
    v_readfirstlane_b32 s35, v13
    s_cmp_eq_u32 s35, 4
    s_cbranch_scc1 F_sqb
    s_sleep 1
    s_branch F_spb
F_sqb:
    s_waitcnt vmcnt(0)
    ds_read_b128 v[144:147], v9 offset:3584
    ds_read_b64 v[112:113], v8 offset:0
    ds_read_b64 v[114:115], v8 offset:8
    ds_read_b128 v[148:151], v9 offset:3072
    ds_read_b64 v[116:117], v8 offset:512
    ds_read_b64 v[118:119], v8 offset:520
    ds_read_b128 v[152:155], v9 offset:2560
    ds_read_b64 v[120:121], v8 offset:1024
    ds_read_b64 v[122:123], v8 offset:1032
    ds_read_b128 v[156:159], v9 offset:2048
    ds_read_b64 v[124:125], v8 offset:1536
    ds_read_b64 v[126:127], v8 offset:1544
    ds_read_b128 v[160:163], v9 offset:1536
    ds_read_b64 v[128:129], v8 offset:2048
    ds_read_b64 v[130:131], v8 offset:2056
    ds_read_b128 v[164:167], v9 offset:1024
    ds_read_b64 v[132:133], v8 offset:2560
    ds_read_b64 v[134:135], v8 offset:2568
    ds_read_b128 v[168:171], v9 offset:512
    ds_read_b64 v[136:137], v8 offset:3072
    ds_read_b64 v[138:139], v8 offset:3080
    ds_read_b128 v[172:175], v9 offset:0
    ds_read_b64 v[140:141], v8 offset:3584
    ds_read_b64 v[142:143], v8 offset:3592
    s_mov_b32 s35, 0
F_loop:
    s_waitcnt lgkmcnt(0)
    v_mfma_f32_16x16x32_bf16 v[80:83], v[112:115], v[144:147], v[80:83]
    ds_read_b128 v[208:211], v9 offset:3648
    v_mfma_f32_16x16x32_bf16 v[84:87], v[112:115], v[148:151], v[84:87]
    ds_read_b64 v[176:177], v8 offset:64
    v_mfma_f32_16x16x32_bf16 v[88:91], v[112:115], v[152:155], v[88:91]
    ds_read_b64 v[178:179], v8 offset:72
    v_mfma_f32_16x16x32_bf16 v[92:95], v[112:115], v[156:159], v[92:95]
    ds_read_b128 v[212:215], v9 offset:3136
    v_mfma_f32_16x16x32_bf16 v[96:99], v[112:115], v[160:163], v[96:99]
    ds_read_b64 v[180:181], v8 offset:576
    v_mfma_f32_16x16x32_bf16 v[100:103], v[112:115], v[164:167], v[100:103]
    ds_read_b64 v[182:183], v8 offset:584
    v_mfma_f32_16x16x32_bf16 v[104:107], v[112:115], v[168:171], v[104:107]
    ds_read_b128 v[216:219], v9 offset:2624
    v_mfma_f32_16x16x32_bf16 v[108:111], v[112:115], v[172:175], v[108:111]
    ds_read_b64 v[184:185], v8 offset:1088
    v_mfma_f32_16x16x32_bf16 v[84:87], v[116:119], v[144:147], v[84:87]
    ds_read_b64 v[186:187], v8 offset:1096
    v_mfma_f32_16x16x32_bf16 v[88:91], v[116:119], v[148:151], v[88:91]
    ds_read_b128 v[220:223], v9 offset:2112
    v_mfma_f32_16x16x32_bf16 v[92:95], v[116:119], v[152:155], v[92:95]
    ds_read_b64 v[188:189], v8 offset:1600
    v_mfma_f32_16x16x32_bf16 v[96:99], v[116:119], v[156:159], v[96:99]
    ds_read_b64 v[190:191], v8 offset:1608
    v_mfma_f32_16x16x32_bf16 v[100:103], v[116:119], v[160:163], v[100:103]
    ds_read_b128 v[224:227], v9 offset:1600
    v_mfma_f32_16x16x32_bf16 v[104:107], v[116:119], v[164:167], v[104:107]
    ds_read_b64 v[192:193], v8 offset:2112
    v_mfma_f32_16x16x32_bf16 v[108:111], v[116:119], v[168:171], v[108:111]
    ds_read_b64 v[194:195], v8 offset:2120
    v_mfma_f32_16x16x32_bf16 v[88:91], v[120:123], v[144:147], v[88:91]
    ds_read_b128 v[228:231], v9 offset:1088
    v_mfma_f32_16x16x32_bf16 v[92:95], v[120:123], v[148:151], v[92:95]
    ds_read_b64 v[196:197], v8 offset:2624
    v_mfma_f32_16x16x32_bf16 v[96:99], v[120:123], v[152:155], v[96:99]
    ds_read_b64 v[198:199], v8 offset:2632
    v_mfma_f32_16x16x32_bf16 v[100:103], v[120:123], v[156:159], v[100:103]
    ds_read_b128 v[232:235], v9 offset:576
    v_mfma_f32_16x16x32_bf16 v[104:107], v[120:123], v[160:163], v[104:107]
    ds_read_b64 v[200:201], v8 offset:3136
    v_mfma_f32_16x16x32_bf16 v[108:111], v[120:123], v[164:167], v[108:111]
    ds_read_b64 v[202:203], v8 offset:3144
    v_mfma_f32_16x16x32_bf16 v[92:95], v[124:127], v[144:147], v[92:95]
    ds_read_b128 v[236:239], v9 offset:64
    v_mfma_f32_16x16x32_bf16 v[96:99], v[124:127], v[148:151], v[96:99]
    ds_read_b64 v[204:205], v8 offset:3648
    v_mfma_f32_16x16x32_bf16 v[100:103], v[124:127], v[152:155], v[100:103]
    ds_read_b64 v[206:207], v8 offset:3656
    v_mfma_f32_16x16x32_bf16 v[104:107], v[124:127], v[156:159], v[104:107]
    ds_read_b32 v35, v10 offset:20
    v_mfma_f32_16x16x32_bf16 v[108:111], v[124:127], v[160:163], v[108:111]
    v_add_u32 v8, 128, v8
    v_mfma_f32_16x16x32_bf16 v[96:99], v[128:131], v[144:147], v[96:99]
    v_add_u32 v9, 128, v9
    v_mfma_f32_16x16x32_bf16 v[100:103], v[128:131], v[148:151], v[100:103]
    s_add_u32 s35, s35, 1
    v_mfma_f32_16x16x32_bf16 v[104:107], v[128:131], v[152:155], v[104:107]
    s_cmp_eq_u32 s35, 4
    v_mfma_f32_16x16x32_bf16 v[108:111], v[128:131], v[156:159], v[108:111]
    v_mfma_f32_16x16x32_bf16 v[100:103], v[132:135], v[144:147], v[100:103]
    v_mfma_f32_16x16x32_bf16 v[104:107], v[132:135], v[148:151], v[104:107]
    v_mfma_f32_16x16x32_bf16 v[108:111], v[132:135], v[152:155], v[108:111]
    v_mfma_f32_16x16x32_bf16 v[104:107], v[136:139], v[144:147], v[104:107]
    v_mfma_f32_16x16x32_bf16 v[108:111], v[136:139], v[148:151], v[108:111]
    v_mfma_f32_16x16x32_bf16 v[108:111], v[140:143], v[144:147], v[108:111]
    s_waitcnt lgkmcnt(0)
    s_cbranch_scc1 F_fin
    v_mfma_f32_16x16x32_bf16 v[80:83], v[176:179], v[208:211], v[80:83]
    ds_read_b128 v[144:147], v9 offset:3584
    v_mfma_f32_16x16x32_bf16 v[84:87], v[176:179], v[212:215], v[84:87]
    ds_read_b64 v[112:113], v8 offset:0
    v_mfma_f32_16x16x32_bf16 v[88:91], v[176:179], v[216:219], v[88:91]
    ds_read_b64 v[114:115], v8 offset:8
    v_mfma_f32_16x16x32_bf16 v[92:95], v[176:179], v[220:223], v[92:95]
    ds_read_b128 v[148:151], v9 offset:3072
    v_mfma_f32_16x16x32_bf16 v[96:99], v[176:179], v[224:227], v[96:99]
    ds_read_b64 v[116:117], v8 offset:512
    v_mfma_f32_16x16x32_bf16 v[100:103], v[176:179], v[228:231], v[100:103]
    ds_read_b64 v[118:119], v8 offset:520
    v_mfma_f32_16x16x32_bf16 v[104:107], v[176:179], v[232:235], v[104:107]
    ds_read_b128 v[152:155], v9 offset:2560
    v_mfma_f32_16x16x32_bf16 v[108:111], v[176:179], v[236:239], v[108:111]
    ds_read_b64 v[120:121], v8 offset:1024
    v_mfma_f32_16x16x32_bf16 v[84:87], v[180:183], v[208:211], v[84:87]
    ds_read_b64 v[122:123], v8 offset:1032
    v_mfma_f32_16x16x32_bf16 v[88:91], v[180:183], v[212:215], v[88:91]
    ds_read_b128 v[156:159], v9 offset:2048
    v_mfma_f32_16x16x32_bf16 v[92:95], v[180:183], v[216:219], v[92:95]
    ds_read_b64 v[124:125], v8 offset:1536
    v_mfma_f32_16x16x32_bf16 v[96:99], v[180:183], v[220:223], v[96:99]
    ds_read_b64 v[126:127], v8 offset:1544
    v_mfma_f32_16x16x32_bf16 v[100:103], v[180:183], v[224:227], v[100:103]
    ds_read_b128 v[160:163], v9 offset:1536
    v_mfma_f32_16x16x32_bf16 v[104:107], v[180:183], v[228:231], v[104:107]
    ds_read_b64 v[128:129], v8 offset:2048
    v_mfma_f32_16x16x32_bf16 v[108:111], v[180:183], v[232:235], v[108:111]
    ds_read_b64 v[130:131], v8 offset:2056
    v_mfma_f32_16x16x32_bf16 v[88:91], v[184:187], v[208:211], v[88:91]
    ds_read_b128 v[164:167], v9 offset:1024
    v_mfma_f32_16x16x32_bf16 v[92:95], v[184:187], v[212:215], v[92:95]
    ds_read_b64 v[132:133], v8 offset:2560
    v_mfma_f32_16x16x32_bf16 v[96:99], v[184:187], v[216:219], v[96:99]
    ds_read_b64 v[134:135], v8 offset:2568
    v_mfma_f32_16x16x32_bf16 v[100:103], v[184:187], v[220:223], v[100:103]
    ds_read_b128 v[168:171], v9 offset:512
    v_mfma_f32_16x16x32_bf16 v[104:107], v[184:187], v[224:227], v[104:107]
    ds_read_b64 v[136:137], v8 offset:3072
    v_mfma_f32_16x16x32_bf16 v[108:111], v[184:187], v[228:231], v[108:111]
    ds_read_b64 v[138:139], v8 offset:3080
    v_mfma_f32_16x16x32_bf16 v[92:95], v[188:191], v[208:211], v[92:95]
    ds_read_b128 v[172:175], v9 offset:0
    v_mfma_f32_16x16x32_bf16 v[96:99], v[188:191], v[212:215], v[96:99]
    ds_read_b64 v[140:141], v8 offset:3584
    v_mfma_f32_16x16x32_bf16 v[100:103], v[188:191], v[216:219], v[100:103]
    ds_read_b64 v[142:143], v8 offset:3592
    v_mfma_f32_16x16x32_bf16 v[104:107], v[188:191], v[220:223], v[104:107]
    v_mfma_f32_16x16x32_bf16 v[108:111], v[188:191], v[224:227], v[108:111]
    v_mfma_f32_16x16x32_bf16 v[96:99], v[192:195], v[208:211], v[96:99]
    v_mfma_f32_16x16x32_bf16 v[100:103], v[192:195], v[212:215], v[100:103]
    v_mfma_f32_16x16x32_bf16 v[104:107], v[192:195], v[216:219], v[104:107]
    v_mfma_f32_16x16x32_bf16 v[108:111], v[192:195], v[220:223], v[108:111]
    v_mfma_f32_16x16x32_bf16 v[100:103], v[196:199], v[208:211], v[100:103]
    v_mfma_f32_16x16x32_bf16 v[104:107], v[196:199], v[212:215], v[104:107]
    v_mfma_f32_16x16x32_bf16 v[108:111], v[196:199], v[216:219], v[108:111]
    v_mfma_f32_16x16x32_bf16 v[104:107], v[200:203], v[208:211], v[104:107]
    v_mfma_f32_16x16x32_bf16 v[108:111], v[200:203], v[212:215], v[108:111]
    v_mfma_f32_16x16x32_bf16 v[108:111], v[204:207], v[208:211], v[108:111]
    s_branch F_loop
F_fin:
    s_branch F_lasta
F_againa:
    s_sleep 1
    ds_read_b32 v35, v10 offset:20
    s_waitcnt lgkmcnt(0)
F_lasta:
    v_readfirstlane_b32 s76, v35
    s_cmp_eq_u32 s76, 4
    s_cbranch_scc0 F_againa
    v_mfma_f32_16x16x32_bf16 v[80:83], v[176:179], v[208:211], v[80:83]
    s_nop 0
    v_mfma_f32_16x16x32_bf16 v[84:87], v[176:179], v[212:215], v[84:87]
    s_nop 0
    v_mfma_f32_16x16x32_bf16 v[88:91], v[176:179], v[216:219], v[88:91]
    ds_read_b64 v[112:113], v32 offset:3584
    v_mfma_f32_16x16x32_bf16 v[92:95], v[176:179], v[220:223], v[92:95]
    ds_read_b64 v[16:17], v34 offset:0
    v_mfma_f32_16x16x32_bf16 v[96:99], v[176:179], v[224:227], v[96:99]
    ds_read_b128 v[128:131], v33 offset:0
    v_mfma_f32_16x16x32_bf16 v[100:103], v[176:179], v[228:231], v[100:103]
    ds_read_b128 v[44:47], v33 offset:8192
    v_mfma_f32_16x16x32_bf16 v[104:107], v[176:179], v[232:235], v[104:107]
    ds_read_b64 v[114:115], v32 offset:3072
    v_mfma_f32_16x16x32_bf16 v[108:111], v[176:179], v[236:239], v[108:111]
    ds_read_b64 v[18:19], v34 offset:512
    v_mfma_f32_16x16x32_bf16 v[84:87], v[180:183], v[208:211], v[84:87]
    ds_read_b128 v[132:135], v33 offset:1024
    v_mfma_f32_16x16x32_bf16 v[88:91], v[180:183], v[212:215], v[88:91]
    ds_read_b128 v[48:51], v33 offset:9216
    v_mfma_f32_16x16x32_bf16 v[92:95], v[180:183], v[216:219], v[92:95]
    ds_read_b64 v[116:117], v32 offset:2560
    v_mfma_f32_16x16x32_bf16 v[96:99], v[180:183], v[220:223], v[96:99]
    ds_read_b64 v[20:21], v34 offset:1024
    v_mfma_f32_16x16x32_bf16 v[100:103], v[180:183], v[224:227], v[100:103]
    ds_read_b128 v[136:139], v33 offset:2048
    v_mfma_f32_16x16x32_bf16 v[104:107], v[180:183], v[228:231], v[104:107]
    ds_read_b128 v[52:55], v33 offset:10240
    v_mfma_f32_16x16x32_bf16 v[108:111], v[180:183], v[232:235], v[108:111]
    ds_read_b64 v[118:119], v32 offset:2048
    v_mfma_f32_16x16x32_bf16 v[88:91], v[184:187], v[208:211], v[88:91]
    ds_read_b64 v[22:23], v34 offset:1536
    v_mfma_f32_16x16x32_bf16 v[92:95], v[184:187], v[212:215], v[92:95]
    ds_read_b128 v[140:143], v33 offset:3072
    v_mfma_f32_16x16x32_bf16 v[96:99], v[184:187], v[216:219], v[96:99]
    ds_read_b128 v[56:59], v33 offset:11264
    v_mfma_f32_16x16x32_bf16 v[100:103], v[184:187], v[220:223], v[100:103]
    ds_read_b64 v[120:121], v32 offset:1536
    v_mfma_f32_16x16x32_bf16 v[104:107], v[184:187], v[224:227], v[104:107]
    ds_read_b64 v[24:25], v34 offset:2048
    v_mfma_f32_16x16x32_bf16 v[108:111], v[184:187], v[228:231], v[108:111]
    ds_read_b128 v[144:147], v33 offset:4096
    v_mfma_f32_16x16x32_bf16 v[92:95], v[188:191], v[208:211], v[92:95]
    ds_read_b128 v[60:63], v33 offset:12288
    v_mfma_f32_16x16x32_bf16 v[96:99], v[188:191], v[212:215], v[96:99]
    ds_read_b64 v[122:123], v32 offset:1024
    v_mfma_f32_16x16x32_bf16 v[100:103], v[188:191], v[216:219], v[100:103]
    ds_read_b64 v[26:27], v34 offset:2560
    v_mfma_f32_16x16x32_bf16 v[104:107], v[188:191], v[220:223], v[104:107]
    ds_read_b128 v[148:151], v33 offset:5120
    v_mfma_f32_16x16x32_bf16 v[108:111], v[188:191], v[224:227], v[108:111]
    ds_read_b128 v[64:67], v33 offset:13312
    v_mfma_f32_16x16x32_bf16 v[96:99], v[192:195], v[208:211], v[96:99]
    ds_read_b64 v[124:125], v32 offset:512
    v_mfma_f32_16x16x32_bf16 v[100:103], v[192:195], v[212:215], v[100:103]
    ds_read_b64 v[28:29], v34 offset:3072
    v_mfma_f32_16x16x32_bf16 v[104:107], v[192:195], v[216:219], v[104:107]
    ds_read_b128 v[152:155], v33 offset:6144
    v_mfma_f32_16x16x32_bf16 v[108:111], v[192:195], v[220:223], v[108:111]
    ds_read_b128 v[68:71], v33 offset:14336
    v_mfma_f32_16x16x32_bf16 v[100:103], v[196:199], v[208:211], v[100:103]
    ds_read_b64 v[126:127], v32 offset:0
    v_mfma_f32_16x16x32_bf16 v[104:107], v[196:199], v[212:215], v[104:107]
    ds_read_b64 v[30:31], v34 offset:3584
    v_mfma_f32_16x16x32_bf16 v[108:111], v[196:199], v[216:219], v[108:111]
    ds_read_b128 v[156:159], v33 offset:7168
    v_mfma_f32_16x16x32_bf16 v[104:107], v[200:203], v[208:211], v[104:107]
    ds_read_b128 v[72:75], v33 offset:15360
    v_mfma_f32_16x16x32_bf16 v[108:111], v[200:203], v[212:215], v[108:111]
    v_mfma_f32_16x16x32_bf16 v[108:111], v[204:207], v[208:211], v[108:111]
    s_nop 7
    s_waitcnt lgkmcnt(15)
    v_and_b32 v12, 0xffff0000, v113
    v_lshlrev_b32 v13, 16, v113
    v_and_b32 v14, 0xffff0000, v112
    v_lshlrev_b32 v15, 16, v112
    v_fmac_f32 v80, s75, v12
    v_fmac_f32 v81, s75, v13
    v_fmac_f32 v82, s75, v14
    v_fmac_f32 v83, s75, v15
    v_lshlrev_b32 v12, 16, v16
    v_and_b32 v13, 0xffff0000, v16
    v_lshlrev_b32 v14, 16, v17
    v_and_b32 v15, 0xffff0000, v17
    v_pk_mul_f32 v[80:81], v[80:81], v[44:45]
    v_pk_mul_f32 v[82:83], v[82:83], v[46:47]
    v_pk_add_f32 v[128:129], v[12:13], v[128:129] neg_lo:[0,1] neg_hi:[0,1]
    v_pk_add_f32 v[130:131], v[14:15], v[130:131] neg_lo:[0,1] neg_hi:[0,1]
    v_pk_fma_f32 v[12:13], v[128:129], v[80:81], v[12:13]
    v_pk_fma_f32 v[14:15], v[130:131], v[82:83], v[14:15]
    v_cvt_pk_bf16_f32 v224, v12, v13
    v_cvt_pk_bf16_f32 v225, v14, v15
    v_and_b32 v12, 0xffff0000, v115
    v_lshlrev_b32 v13, 16, v115
    v_and_b32 v14, 0xffff0000, v114
    v_lshlrev_b32 v15, 16, v114
    v_fmac_f32 v84, s75, v12
    v_fmac_f32 v85, s75, v13
    v_fmac_f32 v86, s75, v14
    v_fmac_f32 v87, s75, v15
    v_lshlrev_b32 v12, 16, v18
    v_and_b32 v13, 0xffff0000, v18
    v_lshlrev_b32 v14, 16, v19
    v_and_b32 v15, 0xffff0000, v19
    v_pk_mul_f32 v[84:85], v[84:85], v[48:49]
    v_pk_mul_f32 v[86:87], v[86:87], v[50:51]
    v_pk_add_f32 v[132:133], v[12:13], v[132:133] neg_lo:[0,1] neg_hi:[0,1]
    v_pk_add_f32 v[134:135], v[14:15], v[134:135] neg_lo:[0,1] neg_hi:[0,1]
    v_pk_fma_f32 v[12:13], v[132:133], v[84:85], v[12:13]
    v_pk_fma_f32 v[14:15], v[134:135], v[86:87], v[14:15]
    v_cvt_pk_bf16_f32 v226, v12, v13
    v_cvt_pk_bf16_f32 v227, v14, v15
    s_nop 0
    v_permlane16_swap_b32 v224, v226
    v_permlane16_swap_b32 v225, v227
    buffer_store_dwordx4 v[224:227], v42, s[36:39], s34 offen sc1
    s_add_u32 s34, s34, 0x100000
    v_and_b32 v12, 0xffff0000, v117
    v_lshlrev_b32 v13, 16, v117
    v_and_b32 v14, 0xffff0000, v116
    v_lshlrev_b32 v15, 16, v116
    v_fmac_f32 v88, s75, v12
    v_fmac_f32 v89, s75, v13
    v_fmac_f32 v90, s75, v14
    v_fmac_f32 v91, s75, v15
    v_lshlrev_b32 v12, 16, v20
    v_and_b32 v13, 0xffff0000, v20
    v_lshlrev_b32 v14, 16, v21
    v_and_b32 v15, 0xffff0000, v21
    v_pk_mul_f32 v[88:89], v[88:89], v[52:53]
    v_pk_mul_f32 v[90:91], v[90:91], v[54:55]
    v_pk_add_f32 v[136:137], v[12:13], v[136:137] neg_lo:[0,1] neg_hi:[0,1]
    v_pk_add_f32 v[138:139], v[14:15], v[138:139] neg_lo:[0,1] neg_hi:[0,1]
    v_pk_fma_f32 v[12:13], v[136:137], v[88:89], v[12:13]
    v_pk_fma_f32 v[14:15], v[138:139], v[90:91], v[14:15]
    v_cvt_pk_bf16_f32 v228, v12, v13
    v_cvt_pk_bf16_f32 v229, v14, v15
    v_and_b32 v12, 0xffff0000, v119
    v_lshlrev_b32 v13, 16, v119
    v_and_b32 v14, 0xffff0000, v118
    v_lshlrev_b32 v15, 16, v118
    v_fmac_f32 v92, s75, v12
    v_fmac_f32 v93, s75, v13
    v_fmac_f32 v94, s75, v14
    v_fmac_f32 v95, s75, v15
    v_lshlrev_b32 v12, 16, v22
    v_and_b32 v13, 0xffff0000, v22
    v_lshlrev_b32 v14, 16, v23
    v_and_b32 v15, 0xffff0000, v23
    v_pk_mul_f32 v[92:93], v[92:93], v[56:57]
    v_pk_mul_f32 v[94:95], v[94:95], v[58:59]
    v_pk_add_f32 v[140:141], v[12:13], v[140:141] neg_lo:[0,1] neg_hi:[0,1]
    v_pk_add_f32 v[142:143], v[14:15], v[142:143] neg_lo:[0,1] neg_hi:[0,1]
    v_pk_fma_f32 v[12:13], v[140:141], v[92:93], v[12:13]
    v_pk_fma_f32 v[14:15], v[142:143], v[94:95], v[14:15]
    v_cvt_pk_bf16_f32 v230, v12, v13
    v_cvt_pk_bf16_f32 v231, v14, v15
    s_nop 0
    v_permlane16_swap_b32 v228, v230
    v_permlane16_swap_b32 v229, v231
    buffer_store_dwordx4 v[228:231], v42, s[36:39], s34 offen sc1
    s_add_u32 s34, s34, 0x100000
    s_waitcnt lgkmcnt(12)
    v_and_b32 v12, 0xffff0000, v121
    v_lshlrev_b32 v13, 16, v121
    v_and_b32 v14, 0xffff0000, v120
    v_lshlrev_b32 v15, 16, v120
    v_fmac_f32 v96, s75, v12
    v_fmac_f32 v97, s75, v13
    v_fmac_f32 v98, s75, v14
    v_fmac_f32 v99, s75, v15
    v_lshlrev_b32 v12, 16, v24
    v_and_b32 v13, 0xffff0000, v24
    v_lshlrev_b32 v14, 16, v25
    v_and_b32 v15, 0xffff0000, v25
    v_pk_mul_f32 v[96:97], v[96:97], v[60:61]
    v_pk_mul_f32 v[98:99], v[98:99], v[62:63]
    v_pk_add_f32 v[144:145], v[12:13], v[144:145] neg_lo:[0,1] neg_hi:[0,1]
    v_pk_add_f32 v[146:147], v[14:15], v[146:147] neg_lo:[0,1] neg_hi:[0,1]
    v_pk_fma_f32 v[12:13], v[144:145], v[96:97], v[12:13]
    v_pk_fma_f32 v[14:15], v[146:147], v[98:99], v[14:15]
    v_cvt_pk_bf16_f32 v232, v12, v13
    v_cvt_pk_bf16_f32 v233, v14, v15
    s_waitcnt lgkmcnt(8)
    v_and_b32 v12, 0xffff0000, v123
    v_lshlrev_b32 v13, 16, v123
    v_and_b32 v14, 0xffff0000, v122
    v_lshlrev_b32 v15, 16, v122
    v_fmac_f32 v100, s75, v12
    v_fmac_f32 v101, s75, v13
    v_fmac_f32 v102, s75, v14
    v_fmac_f32 v103, s75, v15
    v_lshlrev_b32 v12, 16, v26
    v_and_b32 v13, 0xffff0000, v26
    v_lshlrev_b32 v14, 16, v27
    v_and_b32 v15, 0xffff0000, v27
    v_pk_mul_f32 v[100:101], v[100:101], v[64:65]
    v_pk_mul_f32 v[102:103], v[102:103], v[66:67]
    v_pk_add_f32 v[148:149], v[12:13], v[148:149] neg_lo:[0,1] neg_hi:[0,1]
    v_pk_add_f32 v[150:151], v[14:15], v[150:151] neg_lo:[0,1] neg_hi:[0,1]
    v_pk_fma_f32 v[12:13], v[148:149], v[100:101], v[12:13]
    v_pk_fma_f32 v[14:15], v[150:151], v[102:103], v[14:15]
    v_cvt_pk_bf16_f32 v234, v12, v13
    v_cvt_pk_bf16_f32 v235, v14, v15
    s_nop 0
    v_permlane16_swap_b32 v232, v234
    v_permlane16_swap_b32 v233, v235
    buffer_store_dwordx4 v[232:235], v42, s[36:39], s34 offen sc1
    s_add_u32 s34, s34, 0x100000
    s_waitcnt lgkmcnt(4)
    v_and_b32 v12, 0xffff0000, v125
    v_lshlrev_b32 v13, 16, v125
    v_and_b32 v14, 0xffff0000, v124
    v_lshlrev_b32 v15, 16, v124
    v_fmac_f32 v104, s75, v12
    v_fmac_f32 v105, s75, v13
    v_fmac_f32 v106, s75, v14
    v_fmac_f32 v107, s75, v15
    v_lshlrev_b32 v12, 16, v28
    v_and_b32 v13, 0xffff0000, v28
    v_lshlrev_b32 v14, 16, v29
    v_and_b32 v15, 0xffff0000, v29
    v_pk_mul_f32 v[104:105], v[104:105], v[68:69]
    v_pk_mul_f32 v[106:107], v[106:107], v[70:71]
    v_pk_add_f32 v[152:153], v[12:13], v[152:153] neg_lo:[0,1] neg_hi:[0,1]
    v_pk_add_f32 v[154:155], v[14:15], v[154:155] neg_lo:[0,1] neg_hi:[0,1]
    v_pk_fma_f32 v[12:13], v[152:153], v[104:105], v[12:13]
    v_pk_fma_f32 v[14:15], v[154:155], v[106:107], v[14:15]
    v_cvt_pk_bf16_f32 v236, v12, v13
    v_cvt_pk_bf16_f32 v237, v14, v15
    s_waitcnt lgkmcnt(0)
    v_and_b32 v12, 0xffff0000, v127
    v_lshlrev_b32 v13, 16, v127
    v_and_b32 v14, 0xffff0000, v126
    v_lshlrev_b32 v15, 16, v126
    v_fmac_f32 v108, s75, v12
    v_fmac_f32 v109, s75, v13
    v_fmac_f32 v110, s75, v14
    v_fmac_f32 v111, s75, v15
    v_lshlrev_b32 v12, 16, v30
    v_and_b32 v13, 0xffff0000, v30
    v_lshlrev_b32 v14, 16, v31
    v_and_b32 v15, 0xffff0000, v31
    v_pk_mul_f32 v[108:109], v[108:109], v[72:73]
    v_pk_mul_f32 v[110:111], v[110:111], v[74:75]
    v_pk_add_f32 v[156:157], v[12:13], v[156:157] neg_lo:[0,1] neg_hi:[0,1]
    v_pk_add_f32 v[158:159], v[14:15], v[158:159] neg_lo:[0,1] neg_hi:[0,1]
    v_pk_fma_f32 v[12:13], v[156:157], v[108:109], v[12:13]
    v_pk_fma_f32 v[14:15], v[158:159], v[110:111], v[14:15]
    v_cvt_pk_bf16_f32 v238, v12, v13
    v_cvt_pk_bf16_f32 v239, v14, v15
    s_nop 0
    v_permlane16_swap_b32 v236, v238
    v_permlane16_swap_b32 v237, v239
    buffer_store_dwordx4 v[236:239], v42, s[36:39], s34 offen sc1
    s_add_u32 s34, s34, 0x100000
    s_branch F_done
F_help:
    v_lshlrev_b32 v6, 4, v2
    s_lshl_b32 s27, s25, 6
    s_lshl_b32 s28, s24, 3
    s_add_u32 s27, s27, s28
    s_lshl_b32 s28, s34, 1
    s_add_u32 s27, s27, s28
    s_lshl_b32 s28, s27, 11
    s_mov_b32 s16, s42
    s_mov_b32 s17, s43
    s_mov_b32 s18, 0x400000
    s_mov_b32 s19, 0x00020000
    s_mov_b32 s36, s58
    s_mov_b32 s37, s59
    s_mov_b32 s38, 0x4000000
    s_mov_b32 s39, 0x00020000
    buffer_load_dwordx4 v[96:99], v6, s[16:19], s28 offen offset:0
    buffer_load_dwordx4 v[100:103], v6, s[16:19], s28 offen offset:1024
    buffer_load_dwordx4 v[104:107], v6, s[16:19], s28 offen offset:2048
    buffer_load_dwordx4 v[108:111], v6, s[16:19], s28 offen offset:3072
    s_waitcnt lgkmcnt(0)
    s_mov_b32 s12, s10
    s_mov_b32 s13, s11
    s_mov_b32 s14, 0x400000
    s_mov_b32 s15, 0x00020000
    v_add_u32 v5, s26, v5
    s_mov_b32 s45, 0x10000
    s_mov_b32 s46, 0x18000
    s_lshl_b32 s26, s63, 12
    s_load_dwordx2 s[10:11], s[0:1], 56
    s_lshl_b32 s49, s34, 12
    s_add_u32 s49, s49, 119424
    s_mov_b32 s70, 0x05040100
    s_mov_b32 s71, 0x07060302
    s_mov_b32 s51, 0x3a800000
    s_mov_b32 s50, 0x3727c5ac
    s_lshl_b32 s27, s27, 2
    s_add_u32 s72, s27, 0xc00000
    s_add_u32 s73, s72, 8192
    v_add_u32 v7, s64, v6
    v_mov_b32 v60, 0
    v_mov_b32 v61, 0
    v_mov_b32 v62, 0
    v_mov_b32 v63, 0
    v_mul_u32_u24 v39, 2080, v3
    v_lshl_add_u32 v39, v4, 3, v39
    s_lshl_b32 s27, s34, 6
    s_add_u32 s27, s27, 135808
    v_add_u32 v39, s27, v39
    s_waitcnt lgkmcnt(0)
    s_barrier
    v_mov_b32 v10, 152448
    v_mov_b32 v11, 1
    s_waitcnt vmcnt(4)
    s_mov_b64 exec, 1
    ds_add_u32 v10, v11 offset:32
    s_mov_b64 exec, -1
    s_waitcnt vmcnt(0)
    s_add_u32 m0, s64, 32
    s_nop 0
    buffer_load_dwordx4 v6, s[12:15], s26 offen offset:0 nt lds
    buffer_load_dwordx4 v6, s[12:15], s26 offen offset:1024 nt lds
    buffer_load_dwordx4 v6, s[12:15], s26 offen offset:2048 nt lds
    buffer_load_dwordx4 v6, s[12:15], s26 offen offset:3072 nt lds
    s_waitcnt vmcnt(4)
    v_lshlrev_b32 v112, 16, v96
    v_and_b32 v113, 0xffff0000, v96
    v_lshlrev_b32 v114, 16, v97
    v_and_b32 v115, 0xffff0000, v97
    v_lshlrev_b32 v116, 16, v98
    v_and_b32 v117, 0xffff0000, v98
    v_lshlrev_b32 v118, 16, v99
    v_and_b32 v119, 0xffff0000, v99
    v_lshlrev_b32 v120, 16, v100
    v_and_b32 v121, 0xffff0000, v100
    v_lshlrev_b32 v122, 16, v101
    v_and_b32 v123, 0xffff0000, v101
    v_lshlrev_b32 v124, 16, v102
    v_and_b32 v125, 0xffff0000, v102
    v_lshlrev_b32 v126, 16, v103
    v_and_b32 v127, 0xffff0000, v103
    v_lshlrev_b32 v128, 16, v104
    v_and_b32 v129, 0xffff0000, v104
    v_lshlrev_b32 v130, 16, v105
    v_and_b32 v131, 0xffff0000, v105
    v_lshlrev_b32 v132, 16, v106
    v_and_b32 v133, 0xffff0000, v106
    v_lshlrev_b32 v134, 16, v107
    v_and_b32 v135, 0xffff0000, v107
    v_lshlrev_b32 v136, 16, v108
    v_and_b32 v137, 0xffff0000, v108
    v_lshlrev_b32 v138, 16, v109
    v_and_b32 v139, 0xffff0000, v109
    v_lshlrev_b32 v140, 16, v110
    v_and_b32 v141, 0xffff0000, v110
    v_lshlrev_b32 v142, 16, v111
    v_and_b32 v143, 0xffff0000, v111
    v_pk_add_f32 v[188:189], v[112:113], v[114:115]
    v_pk_add_f32 v[190:191], v[128:129], v[130:131]
    v_pk_add_f32 v[188:189], v[188:189], v[116:117]
    v_pk_add_f32 v[190:191], v[190:191], v[132:133]
    v_pk_add_f32 v[188:189], v[188:189], v[118:119]
    v_pk_add_f32 v[190:191], v[190:191], v[134:135]
    v_pk_add_f32 v[188:189], v[188:189], v[120:121]
    v_pk_add_f32 v[190:191], v[190:191], v[136:137]
    v_pk_add_f32 v[188:189], v[188:189], v[122:123]
    v_pk_add_f32 v[190:191], v[190:191], v[138:139]
    v_pk_add_f32 v[188:189], v[188:189], v[124:125]
    v_pk_add_f32 v[190:191], v[190:191], v[140:141]
    v_pk_add_f32 v[188:189], v[188:189], v[126:127]
    v_pk_add_f32 v[190:191], v[190:191], v[142:143]
    v_add_f32 v180, v188, v189
    v_add_f32 v181, v190, v191
    s_nop 0
    v_add_f32_dpp v180, v180, v180 quad_perm:[1,0,3,2] row_mask:0xf bank_mask:0xf
    v_add_f32_dpp v181, v181, v181 quad_perm:[1,0,3,2] row_mask:0xf bank_mask:0xf
    s_nop 0
    v_add_f32_dpp v180, v180, v180 quad_perm:[2,3,0,1] row_mask:0xf bank_mask:0xf
    v_add_f32_dpp v181, v181, v181 quad_perm:[2,3,0,1] row_mask:0xf bank_mask:0xf
    s_nop 0
    v_add_f32_dpp v180, v180, v180 row_half_mirror row_mask:0xf bank_mask:0xf
    v_add_f32_dpp v181, v181, v181 row_half_mirror row_mask:0xf bank_mask:0xf
    s_nop 0
    v_add_f32_dpp v180, v180, v180 row_mirror row_mask:0xf bank_mask:0xf
    v_add_f32_dpp v181, v181, v181 row_mirror row_mask:0xf bank_mask:0xf
    s_nop 0
    v_mov_b32 v182, v180
    v_mov_b32 v183, v181
    s_nop 0
    v_permlane16_swap_b32 v182, v180
    v_permlane16_swap_b32 v183, v181
    v_add_f32 v180, v180, v182
    v_add_f32 v181, v181, v183
    v_mov_b32 v182, v180
    v_mov_b32 v183, v181
    s_nop 0
    v_permlane32_swap_b32 v182, v180
    v_permlane32_swap_b32 v183, v181
    v_add_f32 v180, v180, v182
    v_add_f32 v181, v181, v183
    v_mul_f32 v184, s51, v180
    v_mul_f32 v186, s51, v181
    v_pk_add_f32 v[112:113], v[112:113], v[184:185] op_sel_hi:[1,0] neg_lo:[0,1] neg_hi:[0,1]
    v_pk_add_f32 v[128:129], v[128:129], v[186:187] op_sel_hi:[1,0] neg_lo:[0,1] neg_hi:[0,1]
    v_pk_add_f32 v[114:115], v[114:115], v[184:185] op_sel_hi:[1,0] neg_lo:[0,1] neg_hi:[0,1]
    v_pk_add_f32 v[130:131], v[130:131], v[186:187] op_sel_hi:[1,0] neg_lo:[0,1] neg_hi:[0,1]
    v_pk_add_f32 v[116:117], v[116:117], v[184:185] op_sel_hi:[1,0] neg_lo:[0,1] neg_hi:[0,1]
    v_pk_add_f32 v[132:133], v[132:133], v[186:187] op_sel_hi:[1,0] neg_lo:[0,1] neg_hi:[0,1]
    v_pk_add_f32 v[118:119], v[118:119], v[184:185] op_sel_hi:[1,0] neg_lo:[0,1] neg_hi:[0,1]
    v_pk_add_f32 v[134:135], v[134:135], v[186:187] op_sel_hi:[1,0] neg_lo:[0,1] neg_hi:[0,1]
    v_pk_add_f32 v[120:121], v[120:121], v[184:185] op_sel_hi:[1,0] neg_lo:[0,1] neg_hi:[0,1]
    v_pk_add_f32 v[136:137], v[136:137], v[186:187] op_sel_hi:[1,0] neg_lo:[0,1] neg_hi:[0,1]
    v_pk_add_f32 v[122:123], v[122:123], v[184:185] op_sel_hi:[1,0] neg_lo:[0,1] neg_hi:[0,1]
    v_pk_add_f32 v[138:139], v[138:139], v[186:187] op_sel_hi:[1,0] neg_lo:[0,1] neg_hi:[0,1]
    v_pk_add_f32 v[124:125], v[124:125], v[184:185] op_sel_hi:[1,0] neg_lo:[0,1] neg_hi:[0,1]
    v_pk_add_f32 v[140:141], v[140:141], v[186:187] op_sel_hi:[1,0] neg_lo:[0,1] neg_hi:[0,1]
    v_pk_add_f32 v[126:127], v[126:127], v[184:185] op_sel_hi:[1,0] neg_lo:[0,1] neg_hi:[0,1]
    v_pk_add_f32 v[142:143], v[142:143], v[186:187] op_sel_hi:[1,0] neg_lo:[0,1] neg_hi:[0,1]
    v_pk_mul_f32 v[188:189], v[112:113], v[112:113]
    v_pk_mul_f32 v[190:191], v[128:129], v[128:129]
    v_pk_fma_f32 v[188:189], v[114:115], v[114:115], v[188:189]
    v_pk_fma_f32 v[190:191], v[130:131], v[130:131], v[190:191]
    v_pk_fma_f32 v[188:189], v[116:117], v[116:117], v[188:189]
    v_pk_fma_f32 v[190:191], v[132:133], v[132:133], v[190:191]
    v_pk_fma_f32 v[188:189], v[118:119], v[118:119], v[188:189]
    v_pk_fma_f32 v[190:191], v[134:135], v[134:135], v[190:191]
    v_pk_fma_f32 v[188:189], v[120:121], v[120:121], v[188:189]
    v_pk_fma_f32 v[190:191], v[136:137], v[136:137], v[190:191]
    v_pk_fma_f32 v[188:189], v[122:123], v[122:123], v[188:189]
    v_pk_fma_f32 v[190:191], v[138:139], v[138:139], v[190:191]
    v_pk_fma_f32 v[188:189], v[124:125], v[124:125], v[188:189]
    v_pk_fma_f32 v[190:191], v[140:141], v[140:141], v[190:191]
    v_pk_fma_f32 v[188:189], v[126:127], v[126:127], v[188:189]
    v_pk_fma_f32 v[190:191], v[142:143], v[142:143], v[190:191]
    v_add_f32 v180, v188, v189
    v_add_f32 v181, v190, v191
    s_nop 0
    v_add_f32_dpp v180, v180, v180 quad_perm:[1,0,3,2] row_mask:0xf bank_mask:0xf
    v_add_f32_dpp v181, v181, v181 quad_perm:[1,0,3,2] row_mask:0xf bank_mask:0xf
    s_nop 0
    v_add_f32_dpp v180, v180, v180 quad_perm:[2,3,0,1] row_mask:0xf bank_mask:0xf
    v_add_f32_dpp v181, v181, v181 quad_perm:[2,3,0,1] row_mask:0xf bank_mask:0xf
    s_nop 0
    v_add_f32_dpp v180, v180, v180 row_half_mirror row_mask:0xf bank_mask:0xf
    v_add_f32_dpp v181, v181, v181 row_half_mirror row_mask:0xf bank_mask:0xf
    s_nop 0
    v_add_f32_dpp v180, v180, v180 row_mirror row_mask:0xf bank_mask:0xf
    v_add_f32_dpp v181, v181, v181 row_mirror row_mask:0xf bank_mask:0xf
    s_nop 0
    v_mov_b32 v182, v180
    v_mov_b32 v183, v181
    s_nop 0
    v_permlane16_swap_b32 v182, v180
    v_permlane16_swap_b32 v183, v181
    v_add_f32 v180, v180, v182
    v_add_f32 v181, v181, v183
    v_mov_b32 v182, v180
    v_mov_b32 v183, v181
    s_nop 0
    v_permlane32_swap_b32 v182, v180
    v_permlane32_swap_b32 v183, v181
    v_add_f32 v180, v180, v182
    v_add_f32 v181, v181, v183
    v_mov_b32 v192, v184
    v_cvt_pk_bf16_f32 v192, v192, v192
    v_and_b32 v192, 0xffff0000, v192
    v_mul_f32 v194, s51, v180
    v_cvt_pk_bf16_f32 v194, v194, v194
    v_and_b32 v194, 0xffff0000, v194
    v_add_f32 v194, s50, v194
    v_cvt_pk_bf16_f32 v194, v194, v194
    v_and_b32 v194, 0xffff0000, v194
    v_mov_b32 v193, v186
    v_cvt_pk_bf16_f32 v193, v193, v193
    v_and_b32 v193, 0xffff0000, v193
    v_mul_f32 v195, s51, v181
    v_cvt_pk_bf16_f32 v195, v195, v195
    v_and_b32 v195, 0xffff0000, v195
    v_add_f32 v195, s50, v195
    v_cvt_pk_bf16_f32 v195, v195, v195
    v_and_b32 v195, 0xffff0000, v195
    v_sqrt_f32 v194, v194
    v_sqrt_f32 v195, v195
    s_nop 0
    v_cvt_pk_bf16_f32 v194, v194, v194
    v_and_b32 v194, 0xffff0000, v194
    v_cvt_pk_bf16_f32 v195, v195, v195
    v_and_b32 v195, 0xffff0000, v195
    v_rcp_f32 v194, v194
    v_rcp_f32 v195, v195
    v_mov_b32 v12, 0
    s_mov_b64 exec, 1
    buffer_store_dwordx2 v[192:193], v12, s[36:39], s72 offen sc1
    buffer_store_dwordx2 v[194:195], v12, s[36:39], s73 offen sc1
    s_mov_b64 exec, -1
    s_mul_i32 s35, s34, 1040
    s_add_u32 m0, s35, 135808
    s_nop 0
    buffer_load_dwordx4 v5, s[16:19], 0 offen lds
    s_add_u32 m0, s35, 139968
    s_nop 0
    buffer_load_dwordx4 v5, s[16:19], s44 offen lds
    s_add_u32 m0, s35, 144128
    s_nop 0
    buffer_load_dwordx4 v5, s[16:19], s45 offen lds
    s_add_u32 m0, s35, 148288
    s_nop 0
    buffer_load_dwordx4 v5, s[16:19], s46 offen lds
    v_mov_b32 v10, 152448
    v_mov_b32 v11, 1
    s_waitcnt vmcnt(6)
    ds_read_b128 v[16:19], v7 offset:32
    ds_read_b64 v[20:21], v7 offset:48
    ds_read_b128 v[24:27], v7 offset:1056
    ds_read_b64 v[28:29], v7 offset:1072
    ds_read_b128 v[32:35], v7 offset:2080
    ds_read_b64 v[36:37], v7 offset:2096
    ds_read_b128 v[40:43], v7 offset:3104
    ds_read_b64 v[44:45], v7 offset:3120
    s_waitcnt lgkmcnt(6)
    v_alignbit_b32 v196, v17, v16, 16
    v_alignbit_b32 v197, v18, v17, 16
    v_alignbit_b32 v198, v19, v18, 16
    v_alignbit_b32 v199, v20, v19, 16
    ds_write_b128 v7, v[196:199] offset:4192
    v_mov_b32 v200, v17
    v_mov_b32 v201, v18
    v_mov_b32 v202, v19
    v_mov_b32 v203, v20
    ds_write_b128 v7, v[200:203] offset:8352
    v_alignbit_b32 v204, v18, v17, 16
    v_alignbit_b32 v205, v19, v18, 16
    v_alignbit_b32 v206, v20, v19, 16
    v_alignbit_b32 v207, v21, v20, 16
    ds_write_b128 v7, v[204:207] offset:12512
    v_mov_b32 v68, 0
    v_mov_b32 v69, 0
    v_mov_b32 v70, 0
    v_lshlrev_b32 v71, 16, v16
    v_mov_b32 v72, 0
    v_mov_b32 v73, 0
    v_mov_b32 v74, 0
    v_mov_b32 v75, v16
    v_mov_b32 v76, 0
    v_mov_b32 v77, 0
    v_mov_b32 v78, v71
    v_mov_b32 v79, v196
    s_mov_b64 exec, 1
    ds_write_b128 v7, v[60:63]
    ds_write_b128 v7, v[60:63] offset:16
    ds_write_b128 v7, v[60:63] offset:4160
    ds_write_b128 v7, v[68:71] offset:4176
    ds_write_b128 v7, v[60:63] offset:8320
    ds_write_b128 v7, v[72:75] offset:8336
    ds_write_b128 v7, v[60:63] offset:12480
    ds_write_b128 v7, v[76:79] offset:12496
    s_mov_b64 exec, -1
    s_waitcnt lgkmcnt(15)
    v_alignbit_b32 v208, v25, v24, 16
    v_alignbit_b32 v209, v26, v25, 16
    v_alignbit_b32 v210, v27, v26, 16
    v_alignbit_b32 v211, v28, v27, 16
    ds_write_b128 v7, v[208:211] offset:5216
    v_mov_b32 v212, v25
    v_mov_b32 v213, v26
    v_mov_b32 v214, v27
    v_mov_b32 v215, v28
    ds_write_b128 v7, v[212:215] offset:9376
    v_alignbit_b32 v216, v26, v25, 16
    v_alignbit_b32 v217, v27, v26, 16
    v_alignbit_b32 v218, v28, v27, 16
    v_alignbit_b32 v219, v29, v28, 16
    ds_write_b128 v7, v[216:219] offset:13536
    s_waitcnt lgkmcnt(15)
    v_alignbit_b32 v196, v33, v32, 16
    v_alignbit_b32 v197, v34, v33, 16
    v_alignbit_b32 v198, v35, v34, 16
    v_alignbit_b32 v199, v36, v35, 16
    ds_write_b128 v7, v[196:199] offset:6240
    v_mov_b32 v200, v33
    v_mov_b32 v201, v34
    v_mov_b32 v202, v35
    v_mov_b32 v203, v36
    ds_write_b128 v7, v[200:203] offset:10400
    v_alignbit_b32 v204, v34, v33, 16
    v_alignbit_b32 v205, v35, v34, 16
    v_alignbit_b32 v206, v36, v35, 16
    v_alignbit_b32 v207, v37, v36, 16
    ds_write_b128 v7, v[204:207] offset:14560
    s_waitcnt lgkmcnt(15)
    v_alignbit_b32 v208, v41, v40, 16
    v_alignbit_b32 v209, v42, v41, 16
    v_alignbit_b32 v210, v43, v42, 16
    v_alignbit_b32 v211, v44, v43, 16
    ds_write_b128 v7, v[208:211] offset:7264
    v_mov_b32 v212, v41
    v_mov_b32 v213, v42
    v_mov_b32 v214, v43
    v_mov_b32 v215, v44
    ds_write_b128 v7, v[212:215] offset:11424
    v_alignbit_b32 v216, v42, v41, 16
    v_alignbit_b32 v217, v43, v42, 16
    v_alignbit_b32 v218, v44, v43, 16
    v_alignbit_b32 v219, v45, v44, 16
    ds_write_b128 v7, v[216:219] offset:15584
    s_waitcnt lgkmcnt(0)
    s_mov_b64 exec, 1
    ds_add_u32 v10, v11 offset:8
    s_mov_b64 exec, -1
    s_waitcnt vmcnt(4)
    v_mov_b32 v10, 152448
    v_mov_b32 v11, 1
    v_mov_b32 v12, 0
    s_mov_b64 exec, 1
    ds_add_rtn_u32 v13, v10, v11 offset:36
    s_mov_b64 exec, -1
    s_waitcnt lgkmcnt(0)
    v_readfirstlane_b32 s35, v13
    s_cmp_eq_u32 s35, 3
    s_cbranch_scc0 F_nsf
F_spc:
    ds_read_b32 v13, v10 offset:44
    s_waitcnt lgkmcnt(0)
    v_readfirstlane_b32 s35, v13
    s_cmp_eq_u32 s35, 1
    s_cbranch_scc1 F_sqc
    s_sleep 1
    s_branch F_spc
F_sqc:
    s_lshl_b32 s27, s62, 5
    s_add_u32 s27, s27, 0xcc8000
    s_mov_b64 exec, 1
    buffer_store_dword v11, v12, s[36:39], s27 offen sc1
    s_mov_b64 exec, -1
    s_waitcnt vmcnt(1)
    s_branch F_nsg
F_nsf:
    s_waitcnt vmcnt(0)
F_nsg:
    s_mov_b64 exec, 1
    ds_add_u32 v10, v11 offset:40
    s_mov_b64 exec, -1
F_spt:
    ds_read_b32 v12, v10 offset:40
    s_waitcnt lgkmcnt(0)
    v_readfirstlane_b32 s35, v12
    s_cmp_eq_u32 s35, 4
    s_cbranch_scc1 F_sqt
    s_sleep 1
    s_branch F_spt
F_sqt:
    ds_read_b64 v[80:81], v39 offset:0
    ds_read_b64 v[82:83], v39 offset:256
    ds_read_b64 v[84:85], v39 offset:512
    ds_read_b64 v[86:87], v39 offset:768
    ds_read_b64 v[88:89], v39 offset:1040
    ds_read_b64 v[90:91], v39 offset:1296
    ds_read_b64 v[92:93], v39 offset:1552
    ds_read_b64 v[94:95], v39 offset:1808
    v_mov_b32 v13, v3
    v_lshlrev_b32 v13, 4, v13
    v_lshl_add_u32 v13, v4, 14, v13
    s_lshl_b32 s47, s24, 19
    s_lshl_b32 s48, s34, 17
    s_add_u32 s47, s47, s48
    s_lshl_b32 s48, s25, 7
    s_add_u32 s48, s48, 0x400000
    s_add_u32 s47, s47, s48
    s_waitcnt lgkmcnt(0)
    v_perm_b32 v144, v82, v80, s70
    v_perm_b32 v145, v86, v84, s70
    v_perm_b32 v146, v90, v88, s70
    v_perm_b32 v147, v94, v92, s70
    buffer_store_dwordx4 v[144:147], v13, s[36:39], s47 offen sc1
    s_add_u32 s47, s47, 4096
    v_perm_b32 v148, v82, v80, s71
    v_perm_b32 v149, v86, v84, s71
    v_perm_b32 v150, v90, v88, s71
    v_perm_b32 v151, v94, v92, s71
    buffer_store_dwordx4 v[148:151], v13, s[36:39], s47 offen sc1
    s_add_u32 s47, s47, 4096
    v_perm_b32 v152, v83, v81, s70
    v_perm_b32 v153, v87, v85, s70
    v_perm_b32 v154, v91, v89, s70
    v_perm_b32 v155, v95, v93, s70
    buffer_store_dwordx4 v[152:155], v13, s[36:39], s47 offen sc1
    s_add_u32 s47, s47, 4096
    v_perm_b32 v156, v83, v81, s71
    v_perm_b32 v157, v87, v85, s71
    v_perm_b32 v158, v91, v89, s71
    v_perm_b32 v159, v95, v93, s71
    buffer_store_dwordx4 v[156:159], v13, s[36:39], s47 offen sc1
    s_add_u32 s47, s47, 4096
    s_waitcnt vmcnt(0)
    v_mov_b32 v10, 152448
    v_mov_b32 v11, 1
    v_mov_b32 v12, 0
    s_mov_b64 exec, 1
    ds_add_rtn_u32 v13, v10, v11 offset:12
    s_mov_b64 exec, -1
    s_waitcnt lgkmcnt(0)
    v_readfirstlane_b32 s35, v13
    s_cmp_eq_u32 s35, 3
    s_cbranch_scc0 F_w2
F_mdx:
    ds_read_b32 v13, v10 offset:28
    s_waitcnt lgkmcnt(0)
    v_readfirstlane_b32 s65, v13
    s_cmp_eq_u32 s65, 0
    s_cbranch_scc1 F_mdx
    s_sub_u32 s65, s65, 1
    s_lshl_b32 s27, s62, 5
    s_and_b32 s28, s27, 0xfffff000
    s_add_u32 s27, s27, 0xcc0004
    s_add_u32 s28, s28, 0xcc0004
    v_and_b32 v14, 31, v2
    v_lshlrev_b32 v14, 7, v14
    s_mov_b64 exec, 1
    s_cmp_eq_u32 s65, 1
    s_cbranch_scc1 F_slx
    buffer_store_dword v11, v12, s[36:39], s27 offen sc1
    s_branch F_ppx
F_slx:
    buffer_store_dword v11, v12, s[36:39], s27 offen
F_ppx:
    s_mov_b64 exec, -1
    s_cmp_lg_u32 s25, 0
    s_cbranch_scc1 F_plx
    s_add_u32 s27, s28, 0x7ffc
F_sfp:
    buffer_load_dword v15, v14, s[36:39], s27 offen sc1
    s_waitcnt vmcnt(0)
    v_cmp_eq_u32 vcc, 1, v15
    s_cmp_eq_u64 vcc, -1
    s_cbranch_scc0 F_sfp
    s_lshl_b32 s27, s24, 12
    s_add_u32 s27, s27, 0xcd0000
    s_mov_b64 exec, 1
    buffer_store_dword v11, v12, s[36:39], s27 offen sc1
    s_mov_b64 exec, -1
F_plx:
    buffer_load_dword v15, v14, s[36:39], s28 offen sc1
    s_waitcnt vmcnt(0)
    v_cmp_eq_u32 vcc, 1, v15
    s_cmp_eq_u64 vcc, -1
    s_cbranch_scc0 F_plx
    ds_write_b32 v10, v11 offset:16
    s_mov_b32 m0, s49
    s_add_u32 s26, s26, 0x400000
    buffer_load_dwordx4 v6, s[36:39], s26 offen offset:0 sc1 lds
    buffer_load_dwordx4 v6, s[36:39], s26 offen offset:1024 sc1 lds
    buffer_load_dwordx4 v6, s[36:39], s26 offen offset:2048 sc1 lds
    buffer_load_dwordx4 v6, s[36:39], s26 offen offset:3072 sc1 lds
    v_lshlrev_b32 v14, 12, v3
    s_mov_b32 s28, 0xcd0000
F_p3:
    buffer_load_dword v15, v14, s[36:39], s28 offen sc1
    s_waitcnt vmcnt(0)
    v_cmp_eq_u32 vcc, 1, v15
    s_cmp_eq_u64 vcc, -1
    s_cbranch_scc1 F_p3e
    s_sleep 4
    s_branch F_p3
F_p3e:
    ds_write_b32 v10, v11 offset:24
    s_branch F_g2
F_w2:
F_spx:
    ds_read_b32 v13, v10 offset:16
    s_waitcnt lgkmcnt(0)
    v_readfirstlane_b32 s35, v13
    s_cmp_eq_u32 s35, 1
    s_cbranch_scc1 F_sqx
    s_sleep 1
    s_branch F_spx
F_sqx:
    s_mov_b32 m0, s49
    s_add_u32 s26, s26, 0x400000
    buffer_load_dwordx4 v6, s[36:39], s26 offen offset:0 sc1 lds
    buffer_load_dwordx4 v6, s[36:39], s26 offen offset:1024 sc1 lds
    buffer_load_dwordx4 v6, s[36:39], s26 offen offset:2048 sc1 lds
    buffer_load_dwordx4 v6, s[36:39], s26 offen offset:3072 sc1 lds
F_spy:
    ds_read_b32 v13, v10 offset:24
    s_waitcnt lgkmcnt(0)
    v_readfirstlane_b32 s35, v13
    s_cmp_eq_u32 s35, 1
    s_cbranch_scc1 F_sqy
    s_sleep 1
    s_branch F_spy
F_sqy:
F_g2:
    s_lshl_b32 s30, s34, 12
    s_add_u32 m0, s30, 135808
    s_add_u32 s30, s30, 0xc00000
    buffer_load_dwordx4 v6, s[36:39], s30 offen offset:0 sc1 lds
    buffer_load_dwordx4 v6, s[36:39], s30 offen offset:1024 sc1 lds
    buffer_load_dwordx4 v6, s[36:39], s30 offen offset:2048 sc1 lds
    buffer_load_dwordx4 v6, s[36:39], s30 offen offset:3072 sc1 lds
    s_lshl_b32 s47, s2, 10
    s_lshl_b32 s48, s34, 8
    s_add_u32 s47, s47, s48
    s_add_u32 s47, s47, 0xc80000
    v_lshlrev_b32 v14, 2, v2
    v_mov_b32 v15, -1
    buffer_store_dword v15, v14, s[36:39], s47 offen sc1
    s_mul_i32 s47, s2, 560
    s_mul_i32 s48, s34, 140
    s_add_u32 s47, s47, s48
    s_add_u32 s47, s47, 0x2800000
    v_min_u32 v14, 34, v2
    v_lshlrev_b32 v14, 2, v14
    buffer_store_dword v12, v14, s[36:39], s47 offen sc1
    s_and_b32 s25, s2, 15
    s_lshr_b32 s26, s2, 4
    s_mul_i32 s27, s25, 458752
    s_lshl_b32 s28, s26, 9
    s_lshl_b32 s29, s34, 7
    s_add_u32 s28, s28, s29
    s_add_u32 s27, s27, s28
    v_mul_u32_u24 v5, 7168, v4
    v_lshl_add_u32 v5, v3, 4, v5
    s_mul_i32 s30, s25, 14336
    s_lshl_b32 s28, s28, 1
    s_add_u32 s30, s30, s28
    s_add_u32 s30, s30, 0xc10000
    s_cmp_ge_u32 s2, 224
    s_cselect_b32 s27, 0x80000000, s27
    s_cselect_b32 s30, 0x80000000, s30
    s_waitcnt lgkmcnt(0)
    v_lshlrev_b32 v14, 2, v2
    buffer_store_dword v15, v14, s[36:39], s30 offen sc1
    s_mov_b32 s12, s10
    s_mov_b32 s13, s11
    s_mov_b32 s14, 0x700000
    s_mov_b32 s15, 0x00020000
    buffer_load_dwordx4 v[16:19], v5, s[12:15], s27 offen
    s_add_u32 s27, s27, 57344
    buffer_load_dwordx4 v[20:23], v5, s[12:15], s27 offen
    s_add_u32 s27, s27, 57344
    buffer_load_dwordx4 v[24:27], v5, s[12:15], s27 offen
    s_add_u32 s27, s27, 57344
    buffer_load_dwordx4 v[28:31], v5, s[12:15], s27 offen
    s_add_u32 s27, s27, 57344
    buffer_load_dwordx4 v[32:35], v5, s[12:15], s27 offen
    s_add_u32 s27, s27, 57344
    buffer_load_dwordx4 v[36:39], v5, s[12:15], s27 offen
    s_add_u32 s27, s27, 57344
    buffer_load_dwordx4 v[40:43], v5, s[12:15], s27 offen
    s_add_u32 s27, s27, 57344
    buffer_load_dwordx4 v[44:47], v5, s[12:15], s27 offen
    s_add_u32 s27, s27, 57344
    s_waitcnt vmcnt(11)
    s_mov_b64 exec, 1
    ds_add_u32 v10, v11 offset:20
    s_mov_b64 exec, -1
    s_waitcnt vmcnt(8)
    v_mov_b32 v12, 1
    v_mov_b32 v14, 0
    s_mov_b64 exec, 1
    ds_add_rtn_u32 v13, v10, v12 offset:48
    s_waitcnt lgkmcnt(0)
    v_readfirstlane_b32 s76, v13
    s_cmp_eq_u32 s76, 7
    s_cbranch_scc0 F_nohfh
    s_lshl_b32 s77, s62, 5
    s_add_u32 s77, s77, 0xcd8000
    buffer_store_dword v12, v14, s[36:39], s77 offen sc1
F_nohfh:
    s_mov_b64 exec, -1
    s_cmp_ge_u32 s2, 224
    s_cbranch_scc1 F_code
    s_waitcnt vmcnt(7)
    v_lshlrev_b32 v48, 16, v16
    v_and_b32 v49, 0xffff0000, v16
    v_lshlrev_b32 v50, 16, v17
    v_and_b32 v51, 0xffff0000, v17
    v_lshlrev_b32 v52, 16, v18
    v_and_b32 v53, 0xffff0000, v18
    v_lshlrev_b32 v54, 16, v19
    v_and_b32 v55, 0xffff0000, v19
    s_waitcnt vmcnt(6)
    v_lshlrev_b32 v56, 16, v20
    v_and_b32 v57, 0xffff0000, v20
    v_pk_add_f32 v[48:49], v[48:49], v[56:57]
    v_lshlrev_b32 v58, 16, v21
    v_and_b32 v59, 0xffff0000, v21
    v_pk_add_f32 v[50:51], v[50:51], v[58:59]
    v_lshlrev_b32 v56, 16, v22
    v_and_b32 v57, 0xffff0000, v22
    v_pk_add_f32 v[52:53], v[52:53], v[56:57]
    v_lshlrev_b32 v58, 16, v23
    v_and_b32 v59, 0xffff0000, v23
    v_pk_add_f32 v[54:55], v[54:55], v[58:59]
    s_waitcnt vmcnt(5)
    v_lshlrev_b32 v56, 16, v24
    v_and_b32 v57, 0xffff0000, v24
    v_pk_add_f32 v[48:49], v[48:49], v[56:57]
    v_lshlrev_b32 v58, 16, v25
    v_and_b32 v59, 0xffff0000, v25
    v_pk_add_f32 v[50:51], v[50:51], v[58:59]
    v_lshlrev_b32 v56, 16, v26
    v_and_b32 v57, 0xffff0000, v26
    v_pk_add_f32 v[52:53], v[52:53], v[56:57]
    v_lshlrev_b32 v58, 16, v27
    v_and_b32 v59, 0xffff0000, v27
    v_pk_add_f32 v[54:55], v[54:55], v[58:59]
    s_waitcnt vmcnt(4)
    v_lshlrev_b32 v56, 16, v28
    v_and_b32 v57, 0xffff0000, v28
    v_pk_add_f32 v[48:49], v[48:49], v[56:57]
    v_lshlrev_b32 v58, 16, v29
    v_and_b32 v59, 0xffff0000, v29
    v_pk_add_f32 v[50:51], v[50:51], v[58:59]
    v_lshlrev_b32 v56, 16, v30
    v_and_b32 v57, 0xffff0000, v30
    v_pk_add_f32 v[52:53], v[52:53], v[56:57]
    v_lshlrev_b32 v58, 16, v31
    v_and_b32 v59, 0xffff0000, v31
    v_pk_add_f32 v[54:55], v[54:55], v[58:59]
    s_waitcnt vmcnt(3)
    v_lshlrev_b32 v56, 16, v32
    v_and_b32 v57, 0xffff0000, v32
    v_pk_add_f32 v[48:49], v[48:49], v[56:57]
    v_lshlrev_b32 v58, 16, v33
    v_and_b32 v59, 0xffff0000, v33
    v_pk_add_f32 v[50:51], v[50:51], v[58:59]
    v_lshlrev_b32 v56, 16, v34
    v_and_b32 v57, 0xffff0000, v34
    v_pk_add_f32 v[52:53], v[52:53], v[56:57]
    v_lshlrev_b32 v58, 16, v35
    v_and_b32 v59, 0xffff0000, v35
    v_pk_add_f32 v[54:55], v[54:55], v[58:59]
    s_waitcnt vmcnt(2)
    v_lshlrev_b32 v56, 16, v36
    v_and_b32 v57, 0xffff0000, v36
    v_pk_add_f32 v[48:49], v[48:49], v[56:57]
    v_lshlrev_b32 v58, 16, v37
    v_and_b32 v59, 0xffff0000, v37
    v_pk_add_f32 v[50:51], v[50:51], v[58:59]
    v_lshlrev_b32 v56, 16, v38
    v_and_b32 v57, 0xffff0000, v38
    v_pk_add_f32 v[52:53], v[52:53], v[56:57]
    v_lshlrev_b32 v58, 16, v39
    v_and_b32 v59, 0xffff0000, v39
    v_pk_add_f32 v[54:55], v[54:55], v[58:59]
    s_waitcnt vmcnt(1)
    v_lshlrev_b32 v56, 16, v40
    v_and_b32 v57, 0xffff0000, v40
    v_pk_add_f32 v[48:49], v[48:49], v[56:57]
    v_lshlrev_b32 v58, 16, v41
    v_and_b32 v59, 0xffff0000, v41
    v_pk_add_f32 v[50:51], v[50:51], v[58:59]
    v_lshlrev_b32 v56, 16, v42
    v_and_b32 v57, 0xffff0000, v42
    v_pk_add_f32 v[52:53], v[52:53], v[56:57]
    v_lshlrev_b32 v58, 16, v43
    v_and_b32 v59, 0xffff0000, v43
    v_pk_add_f32 v[54:55], v[54:55], v[58:59]
    s_waitcnt vmcnt(0)
    v_lshlrev_b32 v56, 16, v44
    v_and_b32 v57, 0xffff0000, v44
    v_pk_add_f32 v[48:49], v[48:49], v[56:57]
    v_lshlrev_b32 v58, 16, v45
    v_and_b32 v59, 0xffff0000, v45
    v_pk_add_f32 v[50:51], v[50:51], v[58:59]
    v_lshlrev_b32 v56, 16, v46
    v_and_b32 v57, 0xffff0000, v46
    v_pk_add_f32 v[52:53], v[52:53], v[56:57]
    v_lshlrev_b32 v58, 16, v47
    v_and_b32 v59, 0xffff0000, v47
    v_pk_add_f32 v[54:55], v[54:55], v[58:59]
    v_add_f32_dpp v48, v48, v48 row_ror:8 row_mask:0xf bank_mask:0xf
    v_add_f32_dpp v49, v49, v49 row_ror:8 row_mask:0xf bank_mask:0xf
    v_add_f32_dpp v50, v50, v50 row_ror:8 row_mask:0xf bank_mask:0xf
    v_add_f32_dpp v51, v51, v51 row_ror:8 row_mask:0xf bank_mask:0xf
    v_add_f32_dpp v52, v52, v52 row_ror:8 row_mask:0xf bank_mask:0xf
    v_add_f32_dpp v53, v53, v53 row_ror:8 row_mask:0xf bank_mask:0xf
    v_add_f32_dpp v54, v54, v54 row_ror:8 row_mask:0xf bank_mask:0xf
    v_add_f32_dpp v55, v55, v55 row_ror:8 row_mask:0xf bank_mask:0xf
    v_mov_b32 v56, v48
    v_mov_b32 v57, v49
    v_mov_b32 v58, v50
    v_mov_b32 v59, v51
    v_mov_b32 v60, v52
    v_mov_b32 v61, v53
    v_mov_b32 v62, v54
    v_mov_b32 v63, v55
    v_permlane16_swap_b32 v56, v48
    v_permlane16_swap_b32 v57, v49
    v_permlane16_swap_b32 v58, v50
    v_permlane16_swap_b32 v59, v51
    v_permlane16_swap_b32 v60, v52
    v_permlane16_swap_b32 v61, v53
    v_permlane16_swap_b32 v62, v54
    v_permlane16_swap_b32 v63, v55
    v_add_f32 v48, v48, v56
    v_add_f32 v49, v49, v57
    v_add_f32 v50, v50, v58
    v_add_f32 v51, v51, v59
    v_add_f32 v52, v52, v60
    v_add_f32 v53, v53, v61
    v_add_f32 v54, v54, v62
    v_add_f32 v55, v55, v63
    v_mov_b32 v56, v48
    v_mov_b32 v57, v49
    v_mov_b32 v58, v50
    v_mov_b32 v59, v51
    v_mov_b32 v60, v52
    v_mov_b32 v61, v53
    v_mov_b32 v62, v54
    v_mov_b32 v63, v55
    v_permlane32_swap_b32 v56, v48
    v_permlane32_swap_b32 v57, v49
    v_permlane32_swap_b32 v58, v50
    v_permlane32_swap_b32 v59, v51
    v_permlane32_swap_b32 v60, v52
    v_permlane32_swap_b32 v61, v53
    v_permlane32_swap_b32 v62, v54
    v_permlane32_swap_b32 v63, v55
    v_add_f32 v48, v48, v56
    v_add_f32 v49, v49, v57
    v_add_f32 v50, v50, v58
    v_add_f32 v51, v51, v59
    v_add_f32 v52, v52, v60
    v_add_f32 v53, v53, v61
    v_add_f32 v54, v54, v62
    v_add_f32 v55, v55, v63
    v_min_u32 v48, -2, v48
    v_min_u32 v49, -2, v49
    v_min_u32 v50, -2, v50
    v_min_u32 v51, -2, v51
    v_min_u32 v52, -2, v52
    v_min_u32 v53, -2, v53
    v_min_u32 v54, -2, v54
    v_min_u32 v55, -2, v55
    s_mov_b32 s27, s30
    v_lshlrev_b32 v4, 5, v3
    s_mov_b64 exec, 0xff
    buffer_store_dwordx4 v[48:51], v4, s[36:39], s27 offen sc1
    buffer_store_dwordx4 v[52:55], v4, s[36:39], s27 offen offset:16 sc1
    s_mov_b64 exec, -1
    s_branch F_done2
F_code:
    s_load_dwordx2 s[66:67], s[0:1], 64
    s_load_dwordx2 s[68:69], s[0:1], 80
    v_lshlrev_b32 v13, 7, v2
    v_min_u32 v14, 2044, v13
    v_min_u32 v13, 7164, v13
    s_waitcnt lgkmcnt(0)
    global_load_dword v63, v13, s[66:67]
    global_load_dword v61, v14, s[68:69]
    s_cmp_ge_u32 s2, 232
    s_cbranch_scc1 F_done2
    s_getpc_b64 s[66:67]
F_pc:
    v_and_b32 v13, 255, v0
    v_lshlrev_b32 v13, 7, v13
    v_min_u32 v13, TEXT_END - F_pc - 4, v13
    global_load_dword v62, v13, s[66:67]
    s_branch F_done2
F_done:
    s_waitcnt vmcnt(0)
    v_mov_b32 v12, 1
    v_mov_b32 v14, 0
    s_mov_b64 exec, 1
    ds_add_rtn_u32 v13, v10, v12 offset:48
    s_waitcnt lgkmcnt(0)
    v_readfirstlane_b32 s76, v13
    s_cmp_eq_u32 s76, 7
    s_cbranch_scc0 F_nohfc
    s_lshl_b32 s77, s62, 5
    s_add_u32 s77, s77, 0xcd8000
    buffer_store_dword v12, v14, s[36:39], s77 offen sc1
F_nohfc:
    s_mov_b64 exec, -1
F_done2:
    s_load_dwordx2 s[4:5], s[0:1], 104
    s_load_dwordx4 s[8:11], s[0:1], 56
    s_load_dwordx4 s[48:51], s[0:1], 72
    s_load_dwordx2 s[52:53], s[0:1], 88
    v_lshrrev_b32 v1, 6, v0
    v_and_b32 v2, 63, v0
    s_and_b32 s24, s2, 7
    v_readfirstlane_b32 s33, v1
    s_lshr_b32 s25, s2, 3
    s_and_b32 s26, s24, 1
    s_lshl_b32 s26, s26, 3
    s_and_b32 s27, s25, 7
    s_add_u32 s26, s26, s27
    s_lshr_b32 s27, s24, 1
    s_lshl_b32 s27, s27, 2
    s_lshr_b32 s55, s25, 3
    s_add_u32 s27, s27, s55
    s_lshr_b32 s54, s27, 3
    s_and_b32 s55, s27, 7
    s_lshl_b32 s56, s26, 1
    s_add_u32 s56, s56, s54
    s_lshl_b32 s56, s56, 7
    s_and_b32 s29, s27, 1
    s_cmp_lt_u32 s33, 4
    s_cbranch_scc1 G_cons
    s_and_b32 s34, s33, 3
    s_lshl_b32 s35, s34, 12
    v_lshl_add_u32 v224, v2, 4, s35
    s_lshl_b32 s68, s26, 18
    s_add_u32 s69, s68, 262144
    s_and_b32 s36, s27, 12
    s_lshl_b32 s30, s36, 14
    s_add_u32 s30, s30, s68
    s_mul_i32 s66, s27, 448
    s_and_b32 s66, s66, 0xffffff80
    s_add_u32 s67, s66, 7340032
    s_mul_i32 s31, s36, 458752
    s_add_u32 s31, s31, s66
    s_mov_b32 s70, s35
    s_add_u32 s39, s35, 49152
    s_add_u32 s38, s35, s35
    s_add_u32 s38, s38, 49152
    s_mov_b32 s71, s38
    s_add_u32 s37, s38, 98304
    s_waitcnt lgkmcnt(0)
    s_add_u32 s12, s4, 0x800000
    s_addc_u32 s13, s5, 0
    s_mov_b32 s14, 0x400000
    s_mov_b32 s15, 0x00020000
    v_lshrrev_b32 v8, 5, v2
    s_lshl_b32 s36, s34, 4
    v_add_u32 v9, s36, v8
    v_mul_u32_u24 v9, 7168, v9
    v_and_b32 v10, 1, v2
    v_lshl_add_u32 v9, v10, 4, v9
    v_bfe_u32 v10, v2, 1, 4
    v_xor_b32 v10, v10, v8
    s_mov_b32 s16, s8
    s_mov_b32 s17, s9
    s_mov_b32 s18, 0x700000
    s_mov_b32 s19, 0x00020000
    v_xor_b32 v11, 0, v10
    v_lshl_add_u32 v11, v11, 5, v9
    v_add_u32 v216, 0, v11
    v_add_u32 v218, 26624, v11
    v_xor_b32 v11, 2, v10
    v_lshl_add_u32 v11, v11, 5, v9
    v_add_u32 v217, 13312, v11
    v_add_u32 v219, 39936, v11
    v_xor_b32 v11, 4, v10
    v_lshl_add_u32 v11, v11, 5, v9
    v_add_u32 v220, 57344, v11
    v_add_u32 v222, 83968, v11
    v_xor_b32 v11, 6, v10
    v_lshl_add_u32 v11, v11, 5, v9
    v_add_u32 v221, 70656, v11
    v_add_u32 v223, 97280, v11
    s_add_u32 s20, s4, 0xcd8000
    s_addc_u32 s21, s5, 0
    s_mov_b32 s22, 0x8000
    s_mov_b32 s23, 0x00020000
    s_mov_b32 s60, s48
    s_mov_b32 s61, s49
    s_mov_b32 s62, 0x700000
    s_mov_b32 s63, 0x00020000
    v_mov_b32 v10, 152448
    v_lshlrev_b32 v70, 7, v2
    s_and_b32 s41, s27, 12
    s_lshl_b32 s41, s41, 11
    s_mul_i32 s59, s2, 28672
    s_mul_i32 s36, s34, 7168
    s_add_u32 s59, s59, s36
G_m0:
    ds_read_b32 v13, v10 offset:48
    s_waitcnt lgkmcnt(0)
    v_readfirstlane_b32 s36, v13
    s_cmp_eq_u32 s36, 8
    s_cbranch_scc1 G_m1
    s_sleep 1
    s_branch G_m0
G_m1:
    s_mov_b32 m0, s38
    s_nop 0
    buffer_load_dwordx4 v216, s[16:19], s31 offen offset:0 lds
    buffer_load_dwordx4 v217, s[16:19], s31 offen offset:1024 lds
    buffer_load_dwordx4 v218, s[16:19], s31 offen offset:2048 lds
    buffer_load_dwordx4 v219, s[16:19], s31 offen offset:3072 lds
    s_add_u32 m0, s38, 4096
    s_add_u32 s38, s38, 32768
    buffer_load_dwordx4 v220, s[16:19], s31 offen offset:0 lds
    buffer_load_dwordx4 v221, s[16:19], s31 offen offset:1024 lds
    buffer_load_dwordx4 v222, s[16:19], s31 offen offset:2048 lds
    buffer_load_dwordx4 v223, s[16:19], s31 offen offset:3072 lds
    s_add_u32 s31, s31, 458752
    s_cmp_ge_u32 s38, s37
    s_cselect_b32 s38, s71, s38
    s_cmp_ge_u32 s31, s67
    s_cselect_b32 s31, s66, s31
    s_mov_b32 m0, s38
    s_nop 0
    buffer_load_dwordx4 v216, s[16:19], s31 offen offset:0 lds
    buffer_load_dwordx4 v217, s[16:19], s31 offen offset:1024 lds
    buffer_load_dwordx4 v218, s[16:19], s31 offen offset:2048 lds
    buffer_load_dwordx4 v219, s[16:19], s31 offen offset:3072 lds
    s_add_u32 m0, s38, 4096
    s_add_u32 s38, s38, 32768
    buffer_load_dwordx4 v220, s[16:19], s31 offen offset:0 lds
    buffer_load_dwordx4 v221, s[16:19], s31 offen offset:1024 lds
    buffer_load_dwordx4 v222, s[16:19], s31 offen offset:2048 lds
    buffer_load_dwordx4 v223, s[16:19], s31 offen offset:3072 lds
    s_add_u32 s31, s31, 458752
    s_cmp_ge_u32 s38, s37
    s_cselect_b32 s38, s71, s38
    s_cmp_ge_u32 s31, s67
    s_cselect_b32 s31, s66, s31
    s_lshl_b32 s41, s35, 1
G_m2:
    buffer_load_dword v13, v70, s[20:23], s41 offen sc1
    s_waitcnt vmcnt(0)
    v_cmp_eq_u32 vcc, 1, v13
    s_cmp_eq_u64 vcc, -1
    s_cbranch_scc1 G_m3
    s_sleep 2
    s_branch G_m2
G_m3:
    v_mov_b32 v12, 1
    s_mov_b64 exec, 1
    ds_add_u32 v10, v12 offset:56
    s_mov_b64 exec, -1
G_m5:
    ds_read_b32 v13, v10 offset:56
    s_waitcnt lgkmcnt(0)
    v_readfirstlane_b32 s36, v13
    s_cmp_eq_u32 s36, 4
    s_cbranch_scc0 G_m5
    s_mov_b32 m0, s70
    s_add_u32 s70, s70, 16384
    buffer_load_dwordx4 v224, s[12:15], s30 offen offset:0 sc1 lds
    buffer_load_dwordx4 v224, s[12:15], s30 offen offset:1024 sc1 lds
    buffer_load_dwordx4 v224, s[12:15], s30 offen offset:2048 sc1 lds
    buffer_load_dwordx4 v224, s[12:15], s30 offen offset:3072 sc1 lds
    s_add_u32 s30, s30, 16384
    s_cmp_ge_u32 s70, s39
    s_cselect_b32 s70, s35, s70
    s_cmp_ge_u32 s30, s69
    s_cselect_b32 s30, s68, s30
    s_mov_b32 m0, s70
    s_add_u32 s70, s70, 16384
    buffer_load_dwordx4 v224, s[12:15], s30 offen offset:0 sc1 lds
    buffer_load_dwordx4 v224, s[12:15], s30 offen offset:1024 sc1 lds
    buffer_load_dwordx4 v224, s[12:15], s30 offen offset:2048 sc1 lds
    buffer_load_dwordx4 v224, s[12:15], s30 offen offset:3072 sc1 lds
    s_add_u32 s30, s30, 16384
    s_cmp_ge_u32 s70, s39
    s_cselect_b32 s70, s35, s70
    s_cmp_ge_u32 s30, s69
    s_cselect_b32 s30, s68, s30
    s_waitcnt vmcnt(4)
    s_barrier
    s_mov_b32 m0, s70
    s_add_u32 s70, s70, 16384
    buffer_load_dwordx4 v224, s[12:15], s30 offen offset:0 sc1 lds
    buffer_load_dwordx4 v224, s[12:15], s30 offen offset:1024 sc1 lds
    buffer_load_dwordx4 v224, s[12:15], s30 offen offset:2048 sc1 lds
    buffer_load_dwordx4 v224, s[12:15], s30 offen offset:3072 sc1 lds
    s_add_u32 s30, s30, 16384
    s_cmp_ge_u32 s70, s39
    s_cselect_b32 s70, s35, s70
    s_cmp_ge_u32 s30, s69
    s_cselect_b32 s30, s68, s30
    s_mov_b32 m0, s38
    s_nop 0
    buffer_load_dwordx4 v216, s[16:19], s31 offen offset:0 lds
    buffer_load_dwordx4 v217, s[16:19], s31 offen offset:1024 lds
    buffer_load_dwordx4 v218, s[16:19], s31 offen offset:2048 lds
    buffer_load_dwordx4 v219, s[16:19], s31 offen offset:3072 lds
    s_add_u32 m0, s38, 4096
    s_add_u32 s38, s38, 32768
    buffer_load_dwordx4 v220, s[16:19], s31 offen offset:0 lds
    buffer_load_dwordx4 v221, s[16:19], s31 offen offset:1024 lds
    buffer_load_dwordx4 v222, s[16:19], s31 offen offset:2048 lds
    buffer_load_dwordx4 v223, s[16:19], s31 offen offset:3072 lds
    s_add_u32 s31, s31, 458752
    s_cmp_ge_u32 s38, s37
    s_cselect_b32 s38, s71, s38
    s_cmp_ge_u32 s31, s67
    s_cselect_b32 s31, s66, s31
    v_lshrrev_b32 v3, 4, v2
    s_lshl_b32 s36, s34, 4
    v_add_u32 v4, s36, v3
    v_lshlrev_b32 v4, 11, v4
    v_and_b32 v5, 1, v2
    v_lshl_add_u32 v4, v5, 4, v4
    v_bfe_u32 v5, v2, 1, 3
    v_xor_b32 v5, v5, v3
    v_xor_b32 v6, 0, v5
    v_lshl_add_u32 v6, v6, 5, v4
    v_add_u32 v212, 0, v6
    v_add_u32 v213, 7168, v6
    v_xor_b32 v6, 4, v5
    v_lshl_add_u32 v6, v6, 5, v4
    v_add_u32 v214, 14336, v6
    v_add_u32 v215, 21504, v6
    v_lshrrev_b32 v3, 3, v2
    v_bfe_u32 v4, v2, 1, 2
    v_lshrrev_b32 v5, 1, v3
    v_xor_b32 v4, v4, v5
    v_and_b32 v5, 1, v4
    v_lshrrev_b32 v4, 1, v4
    v_lshl_or_b32 v4, v4, 2, v5
    s_lshl_b32 s36, s54, 1
    v_or_b32 v4, s36, v4
    v_and_b32 v5, 3, v3
    v_xor_b32 v4, v4, v5
    v_lshlrev_b32 v4, 5, v4
    v_and_b32 v5, 1, v2
    v_lshl_add_u32 v4, v5, 4, v4
    v_lshl_add_u32 v208, v3, 8, v4
    v_xor_b32 v209, 128, v208
    v_add_u32 v209, 1024, v209
    v_add_u32 v210, 2048, v208
    v_add_u32 v211, 2048, v209
    v_and_b32 v3, 31, v2
    v_lshrrev_b32 v4, 5, v2
    v_lshlrev_b32 v4, 13, v4
    v_lshl_add_u32 v206, v3, 2, v4
    v_and_b32 v3, 15, v2
    v_min_u32 v3, 13, v3
    v_lshrrev_b32 v4, 4, v2
    v_mul_u32_u24 v207, 14336, v4
    v_lshl_add_u32 v207, v3, 4, v207
    v_lshlrev_b32 v205, 3, v3
    s_mov_b32 s20, s4
    s_mov_b32 s21, s5
    s_mov_b32 s22, 0x4000000
    s_mov_b32 s23, 0x00020000
    s_mov_b32 s72, s10
    s_mov_b32 s73, s11
    s_mov_b32 s74, 0x1c00
    s_mov_b32 s75, 0x00020000
    s_lshl_b32 s41, s26, 14
    s_lshl_b32 s36, s34, 7
    s_add_u32 s41, s41, s36
    s_add_u32 s41, s41, 0xc80000
    s_add_u32 s47, s41, 4096
    s_mul_i32 s42, s27, 896
    s_mul_i32 s36, s34, 224
    s_add_u32 s42, s42, s36
    s_lshr_b32 s43, s42, 1
    s_add_u32 s42, s42, 0xc10000
    s_mov_b32 s40, 0
G_l1:
    s_waitcnt vmcnt(12)
    s_barrier
    s_mov_b32 m0, s70
    s_add_u32 s70, s70, 16384
    buffer_load_dwordx4 v224, s[12:15], s30 offen offset:0 sc1 lds
    buffer_load_dwordx4 v224, s[12:15], s30 offen offset:1024 sc1 lds
    buffer_load_dwordx4 v224, s[12:15], s30 offen offset:2048 sc1 lds
    buffer_load_dwordx4 v224, s[12:15], s30 offen offset:3072 sc1 lds
    s_add_u32 s30, s30, 16384
    s_cmp_ge_u32 s70, s39
    s_cselect_b32 s70, s35, s70
    s_cmp_ge_u32 s30, s69
    s_cselect_b32 s30, s68, s30
    s_mov_b32 m0, s38
    s_nop 0
    buffer_load_dwordx4 v216, s[16:19], s31 offen offset:0 lds
    buffer_load_dwordx4 v217, s[16:19], s31 offen offset:1024 lds
    buffer_load_dwordx4 v218, s[16:19], s31 offen offset:2048 lds
    buffer_load_dwordx4 v219, s[16:19], s31 offen offset:3072 lds
    s_add_u32 m0, s38, 4096
    s_add_u32 s38, s38, 32768
    buffer_load_dwordx4 v220, s[16:19], s31 offen offset:0 lds
    buffer_load_dwordx4 v221, s[16:19], s31 offen offset:1024 lds
    buffer_load_dwordx4 v222, s[16:19], s31 offen offset:2048 lds
    buffer_load_dwordx4 v223, s[16:19], s31 offen offset:3072 lds
    s_add_u32 s31, s31, 458752
    s_cmp_ge_u32 s38, s37
    s_cselect_b32 s38, s71, s38
    s_cmp_ge_u32 s31, s67
    s_cselect_b32 s31, s66, s31
    s_add_u32 s40, s40, 1
    s_cmp_lt_u32 s40, 7
    s_cbranch_scc1 G_l1
    buffer_load_dword v32, v206, s[20:23], s41 offen offset:0 sc1
    buffer_load_dword v33, v206, s[20:23], s41 offen offset:512 sc1
    buffer_load_dword v34, v206, s[20:23], s41 offen offset:1024 sc1
    buffer_load_dword v35, v206, s[20:23], s41 offen offset:1536 sc1
    buffer_load_dword v36, v206, s[20:23], s41 offen offset:2048 sc1
    buffer_load_dword v37, v206, s[20:23], s41 offen offset:2560 sc1
    buffer_load_dword v38, v206, s[20:23], s41 offen offset:3072 sc1
    buffer_load_dword v39, v206, s[20:23], s41 offen offset:3584 sc1
    buffer_load_dword v40, v206, s[20:23], s47 offen offset:0 sc1
    buffer_load_dword v41, v206, s[20:23], s47 offen offset:512 sc1
    buffer_load_dword v42, v206, s[20:23], s47 offen offset:1024 sc1
    buffer_load_dword v43, v206, s[20:23], s47 offen offset:1536 sc1
    buffer_load_dword v44, v206, s[20:23], s47 offen offset:2048 sc1
    buffer_load_dword v45, v206, s[20:23], s47 offen offset:2560 sc1
    buffer_load_dword v46, v206, s[20:23], s47 offen offset:3072 sc1
    buffer_load_dword v47, v206, s[20:23], s47 offen offset:3584 sc1
    s_add_u32 s36, s42, 0
    buffer_load_dwordx4 v[48:51], v207, s[20:23], s36 offen sc1
    s_add_u32 s36, s42, 57344
    buffer_load_dwordx4 v[52:55], v207, s[20:23], s36 offen sc1
    s_add_u32 s36, s42, 114688
    buffer_load_dwordx4 v[56:59], v207, s[20:23], s36 offen sc1
    s_add_u32 s36, s42, 172032
    buffer_load_dwordx4 v[60:63], v207, s[20:23], s36 offen sc1
    buffer_load_dwordx2 v[64:65], v205, s[72:75], s43 offen
    s_waitcnt vmcnt(33)
    s_barrier
    s_mov_b32 m0, s70
    s_add_u32 s70, s70, 16384
    buffer_load_dwordx4 v224, s[12:15], s30 offen offset:0 sc1 lds
    buffer_load_dwordx4 v224, s[12:15], s30 offen offset:1024 sc1 lds
    buffer_load_dwordx4 v224, s[12:15], s30 offen offset:2048 sc1 lds
    buffer_load_dwordx4 v224, s[12:15], s30 offen offset:3072 sc1 lds
    s_add_u32 s30, s30, 16384
    s_cmp_ge_u32 s70, s39
    s_cselect_b32 s70, s35, s70
    s_cmp_ge_u32 s30, s69
    s_cselect_b32 s30, s68, s30
    s_mov_b32 m0, s38
    s_nop 0
    buffer_load_dwordx4 v216, s[16:19], s31 offen offset:0 lds
    buffer_load_dwordx4 v217, s[16:19], s31 offen offset:1024 lds
    buffer_load_dwordx4 v218, s[16:19], s31 offen offset:2048 lds
    buffer_load_dwordx4 v219, s[16:19], s31 offen offset:3072 lds
    s_add_u32 m0, s38, 4096
    s_add_u32 s38, s38, 32768
    buffer_load_dwordx4 v220, s[16:19], s31 offen offset:0 lds
    buffer_load_dwordx4 v221, s[16:19], s31 offen offset:1024 lds
    buffer_load_dwordx4 v222, s[16:19], s31 offen offset:2048 lds
    buffer_load_dwordx4 v223, s[16:19], s31 offen offset:3072 lds
    s_add_u32 s31, s31, 458752
    s_cmp_ge_u32 s38, s37
    s_cselect_b32 s38, s71, s38
    s_cmp_ge_u32 s31, s67
    s_cselect_b32 s31, s66, s31
    s_waitcnt vmcnt(33)
    s_barrier
    s_mov_b32 m0, s70
    s_add_u32 s70, s70, 16384
    buffer_load_dwordx4 v224, s[12:15], s30 offen offset:0 sc1 lds
    buffer_load_dwordx4 v224, s[12:15], s30 offen offset:1024 sc1 lds
    buffer_load_dwordx4 v224, s[12:15], s30 offen offset:2048 sc1 lds
    buffer_load_dwordx4 v224, s[12:15], s30 offen offset:3072 sc1 lds
    s_add_u32 s30, s30, 16384
    s_cmp_ge_u32 s70, s39
    s_cselect_b32 s70, s35, s70
    s_cmp_ge_u32 s30, s69
    s_cselect_b32 s30, s68, s30
    s_mov_b32 m0, s38
    s_nop 0
    buffer_load_dwordx4 v216, s[16:19], s31 offen offset:0 lds
    buffer_load_dwordx4 v217, s[16:19], s31 offen offset:1024 lds
    buffer_load_dwordx4 v218, s[16:19], s31 offen offset:2048 lds
    buffer_load_dwordx4 v219, s[16:19], s31 offen offset:3072 lds
    s_add_u32 m0, s38, 4096
    s_add_u32 s38, s38, 32768
    buffer_load_dwordx4 v220, s[16:19], s31 offen offset:0 lds
    buffer_load_dwordx4 v221, s[16:19], s31 offen offset:1024 lds
    buffer_load_dwordx4 v222, s[16:19], s31 offen offset:2048 lds
    buffer_load_dwordx4 v223, s[16:19], s31 offen offset:3072 lds
    s_add_u32 s31, s31, 458752
    s_cmp_ge_u32 s38, s37
    s_cselect_b32 s38, s71, s38
    s_cmp_ge_u32 s31, s67
    s_cselect_b32 s31, s66, s31
    s_waitcnt vmcnt(12)
    s_barrier
    s_mov_b32 m0, s70
    s_add_u32 s70, s70, 16384
    buffer_load_dwordx4 v224, s[12:15], s30 offen offset:0 sc1 lds
    buffer_load_dwordx4 v224, s[12:15], s30 offen offset:1024 sc1 lds
    buffer_load_dwordx4 v224, s[12:15], s30 offen offset:2048 sc1 lds
    buffer_load_dwordx4 v224, s[12:15], s30 offen offset:3072 sc1 lds
    s_add_u32 s30, s30, 16384
    s_cmp_ge_u32 s70, s39
    s_cselect_b32 s70, s35, s70
    s_cmp_ge_u32 s30, s69
    s_cselect_b32 s30, s68, s30
    s_mov_b32 m0, s38
    s_nop 0
    buffer_load_dwordx4 v216, s[16:19], s31 offen offset:0 lds
    buffer_load_dwordx4 v217, s[16:19], s31 offen offset:1024 lds
    buffer_load_dwordx4 v218, s[16:19], s31 offen offset:2048 lds
    buffer_load_dwordx4 v219, s[16:19], s31 offen offset:3072 lds
    s_add_u32 m0, s38, 4096
    s_add_u32 s38, s38, 32768
    buffer_load_dwordx4 v220, s[16:19], s31 offen offset:0 lds
    buffer_load_dwordx4 v221, s[16:19], s31 offen offset:1024 lds
    buffer_load_dwordx4 v222, s[16:19], s31 offen offset:2048 lds
    buffer_load_dwordx4 v223, s[16:19], s31 offen offset:3072 lds
    s_add_u32 s31, s31, 458752
    s_cmp_ge_u32 s38, s37
    s_cselect_b32 s38, s71, s38
    s_cmp_ge_u32 s31, s67
    s_cselect_b32 s31, s66, s31
G_chk:
    v_max_u32 v3, v32, v33
    v_max3_u32 v3, v3, v34, v35
    v_max3_u32 v3, v3, v36, v37
    v_max3_u32 v3, v3, v38, v39
    v_max3_u32 v3, v3, v40, v41
    v_max3_u32 v3, v3, v42, v43
    v_max3_u32 v3, v3, v44, v45
    v_max3_u32 v3, v3, v46, v47
    v_max3_u32 v3, v3, v48, v49
    v_max3_u32 v3, v3, v50, v51
    v_max3_u32 v3, v3, v52, v53
    v_max3_u32 v3, v3, v54, v55
    v_max3_u32 v3, v3, v56, v57
    v_max3_u32 v3, v3, v58, v59
    v_max3_u32 v3, v3, v60, v61
    v_max3_u32 v3, v3, v62, v63
    v_cmp_eq_u32 vcc, -1, v3
    s_cmp_lg_u64 vcc, 0
    s_cbranch_scc1 G_retry
    v_pk_add_f32 v[32:33], v[32:33], v[34:35]
    v_pk_add_f32 v[32:33], v[32:33], v[36:37]
    v_pk_add_f32 v[32:33], v[32:33], v[38:39]
    v_pk_add_f32 v[32:33], v[32:33], v[40:41]
    v_pk_add_f32 v[32:33], v[32:33], v[42:43]
    v_pk_add_f32 v[32:33], v[32:33], v[44:45]
    v_pk_add_f32 v[32:33], v[32:33], v[46:47]
    v_pk_add_f32 v[48:49], v[48:49], v[52:53]
    v_pk_add_f32 v[50:51], v[50:51], v[54:55]
    v_pk_add_f32 v[48:49], v[48:49], v[56:57]
    s_waitcnt vmcnt(12)
    s_barrier
    s_mov_b32 m0, s70
    s_add_u32 s70, s70, 16384
    buffer_load_dwordx4 v224, s[12:15], s30 offen offset:0 sc1 lds
    buffer_load_dwordx4 v224, s[12:15], s30 offen offset:1024 sc1 lds
    buffer_load_dwordx4 v224, s[12:15], s30 offen offset:2048 sc1 lds
    buffer_load_dwordx4 v224, s[12:15], s30 offen offset:3072 sc1 lds
    s_add_u32 s30, s30, 16384
    s_cmp_ge_u32 s70, s39
    s_cselect_b32 s70, s35, s70
    s_cmp_ge_u32 s30, s69
    s_cselect_b32 s30, s68, s30
    s_mov_b32 m0, s38
    s_nop 0
    buffer_load_dwordx4 v216, s[16:19], s31 offen offset:0 lds
    buffer_load_dwordx4 v217, s[16:19], s31 offen offset:1024 lds
    buffer_load_dwordx4 v218, s[16:19], s31 offen offset:2048 lds
    buffer_load_dwordx4 v219, s[16:19], s31 offen offset:3072 lds
    s_add_u32 m0, s38, 4096
    s_add_u32 s38, s38, 32768
    buffer_load_dwordx4 v220, s[16:19], s31 offen offset:0 lds
    buffer_load_dwordx4 v221, s[16:19], s31 offen offset:1024 lds
    buffer_load_dwordx4 v222, s[16:19], s31 offen offset:2048 lds
    buffer_load_dwordx4 v223, s[16:19], s31 offen offset:3072 lds
    s_add_u32 s31, s31, 458752
    s_cmp_ge_u32 s38, s37
    s_cselect_b32 s38, s71, s38
    s_cmp_ge_u32 s31, s67
    s_cselect_b32 s31, s66, s31
    v_pk_add_f32 v[50:51], v[50:51], v[58:59]
    v_pk_add_f32 v[48:49], v[48:49], v[60:61]
    v_pk_add_f32 v[50:51], v[50:51], v[62:63]
    v_add_f32 v3, v32, v33
    s_mov_b32 s76, 0x3a800000
    v_mov_b32 v4, v3
    v_mov_b32 v52, v48
    v_mov_b32 v53, v49
    v_mov_b32 v54, v50
    v_mov_b32 v55, v51
    v_permlane16_swap_b32 v52, v48
    v_permlane16_swap_b32 v53, v49
    v_permlane16_swap_b32 v54, v50
    v_permlane16_swap_b32 v55, v51
    v_add_f32 v48, v48, v52
    v_add_f32 v49, v49, v53
    v_add_f32 v50, v50, v54
    v_add_f32 v51, v51, v55
    v_mov_b32 v52, v48
    v_mov_b32 v53, v49
    v_mov_b32 v54, v50
    v_mov_b32 v55, v51
    v_permlane32_swap_b32 v52, v48
    s_waitcnt vmcnt(12)
    s_barrier
    s_mov_b32 m0, s70
    s_add_u32 s70, s70, 16384
    buffer_load_dwordx4 v224, s[12:15], s30 offen offset:0 sc1 lds
    buffer_load_dwordx4 v224, s[12:15], s30 offen offset:1024 sc1 lds
    buffer_load_dwordx4 v224, s[12:15], s30 offen offset:2048 sc1 lds
    buffer_load_dwordx4 v224, s[12:15], s30 offen offset:3072 sc1 lds
    s_add_u32 s30, s30, 16384
    s_cmp_ge_u32 s70, s39
    s_cselect_b32 s70, s35, s70
    s_cmp_ge_u32 s30, s69
    s_cselect_b32 s30, s68, s30
    s_mov_b32 m0, s38
    s_nop 0
    buffer_load_dwordx4 v216, s[16:19], s31 offen offset:0 lds
    buffer_load_dwordx4 v217, s[16:19], s31 offen offset:1024 lds
    buffer_load_dwordx4 v218, s[16:19], s31 offen offset:2048 lds
    buffer_load_dwordx4 v219, s[16:19], s31 offen offset:3072 lds
    s_add_u32 m0, s38, 4096
    s_add_u32 s38, s38, 32768
    buffer_load_dwordx4 v220, s[16:19], s31 offen offset:0 lds
    buffer_load_dwordx4 v221, s[16:19], s31 offen offset:1024 lds
    buffer_load_dwordx4 v222, s[16:19], s31 offen offset:2048 lds
    buffer_load_dwordx4 v223, s[16:19], s31 offen offset:3072 lds
    s_add_u32 s31, s31, 458752
    s_cmp_ge_u32 s38, s37
    s_cselect_b32 s38, s71, s38
    s_cmp_ge_u32 s31, s67
    s_cselect_b32 s31, s66, s31
    v_permlane32_swap_b32 v53, v49
    v_permlane32_swap_b32 v54, v50
    v_permlane32_swap_b32 v55, v51
    v_add_f32 v48, v48, v52
    v_add_f32 v49, v49, v53
    v_add_f32 v50, v50, v54
    v_add_f32 v51, v51, v55
    v_permlane32_swap_b32 v4, v3
    v_mul_f32 v6, s76, v4
    v_mul_f32 v7, s76, v3
    v_fma_f32 v7, -v6, v6, v7
    v_max_f32 v7, 0, v7
    v_cvt_pk_bf16_f32 v6, v6, v6
    v_and_b32 v6, 0xffff0000, v6
    v_cvt_pk_bf16_f32 v7, v7, v7
    v_and_b32 v7, 0xffff0000, v7
    v_add_f32 v7, 0x3727c5ac, v7
    v_cvt_pk_bf16_f32 v7, v7, v7
    v_and_b32 v7, 0xffff0000, v7
    v_sqrt_f32 v7, v7
    v_cvt_pk_bf16_f32 v52, v48, v48
    v_cvt_pk_bf16_f32 v53, v49, v49
    v_cvt_pk_bf16_f32 v54, v50, v50
    s_waitcnt vmcnt(12)
    s_barrier
    s_mov_b32 m0, s70
    s_add_u32 s70, s70, 16384
    buffer_load_dwordx4 v224, s[12:15], s30 offen offset:0 sc1 lds
    buffer_load_dwordx4 v224, s[12:15], s30 offen offset:1024 sc1 lds
    buffer_load_dwordx4 v224, s[12:15], s30 offen offset:2048 sc1 lds
    buffer_load_dwordx4 v224, s[12:15], s30 offen offset:3072 sc1 lds
    s_add_u32 s30, s30, 16384
    s_cmp_ge_u32 s70, s39
    s_cselect_b32 s70, s35, s70
    s_cmp_ge_u32 s30, s69
    s_cselect_b32 s30, s68, s30
    s_mov_b32 m0, s38
    s_nop 0
    buffer_load_dwordx4 v216, s[16:19], s31 offen offset:0 lds
    buffer_load_dwordx4 v217, s[16:19], s31 offen offset:1024 lds
    buffer_load_dwordx4 v218, s[16:19], s31 offen offset:2048 lds
    buffer_load_dwordx4 v219, s[16:19], s31 offen offset:3072 lds
    s_add_u32 m0, s38, 4096
    s_add_u32 s38, s38, 32768
    buffer_load_dwordx4 v220, s[16:19], s31 offen offset:0 lds
    buffer_load_dwordx4 v221, s[16:19], s31 offen offset:1024 lds
    buffer_load_dwordx4 v222, s[16:19], s31 offen offset:2048 lds
    buffer_load_dwordx4 v223, s[16:19], s31 offen offset:3072 lds
    s_add_u32 s31, s31, 458752
    s_cmp_ge_u32 s38, s37
    s_cselect_b32 s38, s71, s38
    s_cmp_ge_u32 s31, s67
    s_cselect_b32 s31, s66, s31
    s_mov_b32 exec_lo, 0xffffffff
    s_mov_b32 exec_hi, 0xffffff
    buffer_load_dword v71, v70, s[60:63], s59 offen
    s_mov_b64 exec, -1
    v_cvt_pk_bf16_f32 v55, v51, v51
    v_cvt_pk_bf16_f32 v7, v7, v7
    v_and_b32 v7, 0xffff0000, v7
    v_and_b32 v52, 0xffff0000, v52
    v_sub_f32 v48, v48, v52
    v_and_b32 v53, 0xffff0000, v53
    v_sub_f32 v49, v49, v53
    v_and_b32 v54, 0xffff0000, v54
    v_sub_f32 v50, v50, v54
    v_and_b32 v55, 0xffff0000, v55
    v_sub_f32 v51, v51, v55
    v_rcp_f32 v9, v7
    v_cvt_pk_bf16_f32 v56, v52, v48
    v_and_b32 v57, 0xffff, v64
    v_cvt_pk_bf16_f32 v58, v53, v49
    v_lshrrev_b32 v59, 16, v64
    v_cvt_pk_bf16_f32 v60, v54, v50
    v_and_b32 v61, 0xffff, v65
    v_cvt_pk_bf16_f32 v62, v55, v51
    v_lshrrev_b32 v63, 16, v65
    v_mul_f32 v9, v9, v9
    v_xor_b32 v6, 0x80000000, v6
    v_lshrrev_b32 v4, 16, v6
    s_mov_b32 s16, s48
    s_mov_b32 s17, s49
    s_mov_b32 s18, 0x700000
    s_mov_b32 s19, 0x00020000
    s_lshl_b32 s43, s26, 7
    s_lshl_b32 s44, s54, 5
    s_add_u32 s43, s43, s44
    s_lshl_b32 s44, s33, 2
    s_add_u32 s43, s43, s44
    s_lshl_b32 s43, s43, 11
    s_lshl_b32 s44, s55, 8
    s_add_u32 s43, s43, s44
    s_add_u32 s44, s43, 131072
    s_mul_i32 s58, s55, 7
    s_add_u32 s58, s58, 1
    s_lshr_b32 s58, s58, 1
    s_mul_i32 s66, s54, 3670016
    s_lshl_b32 s36, s55, 8
    s_add_u32 s66, s66, s36
    s_lshl_b32 s31, s58, 17
    s_add_u32 s31, s31, s66
    s_add_u32 s67, s66, 3670016
    s_mov_b32 s78, s31
    s_add_u32 s79, s31, 393216
    s_lshl_b32 s38, s29, 14
    s_add_u32 s38, s38, s35
    s_add_u32 s39, s35, 65536
    s_lshl_b32 s36, s55, 15
    s_lshl_b32 s37, s34, 13
    s_add_u32 s36, s36, s37
    s_add_u32 s42, s36, s68
    s_waitcnt vmcnt(13)
    s_barrier
    s_add_u32 m0, s38, 81920
    s_add_u32 s38, s38, 16384
    buffer_load_dwordx4 v212, s[16:19], s31 offen offset:0 lds
    buffer_load_dwordx4 v213, s[16:19], s31 offen offset:1024 lds
    buffer_load_dwordx4 v214, s[16:19], s31 offen offset:2048 lds
    buffer_load_dwordx4 v215, s[16:19], s31 offen offset:3072 lds
    s_add_u32 s31, s31, 131072
    s_cmp_ge_u32 s38, s39
    s_cselect_b32 s38, s35, s38
    s_cmp_eq_u32 s31, s78
    s_cselect_b32 s31, s79, s31
    v_or_b32 v6, v6, v4
    v_lshrrev_b32 v7, 16, v7
    v_and_b32 v3, 31, v2
    s_lshl_b32 s77, s34, 7
    s_add_u32 s77, s77, 147712
    v_lshl_add_u32 v4, v3, 2, s77
    ds_write_b32 v4, v9
    s_lshl_b32 s77, s34, 8
    s_add_u32 s77, s77, 148224
    v_lshl_add_u32 v4, v3, 3, s77
    ds_write_b64 v4, v[6:7]
    s_mul_i32 s77, s34, 448
    s_add_u32 s77, s77, 149312
    v_lshl_add_u32 v3, v205, 2, s77
    ds_write_b128 v3, v[56:59]
    ds_write_b128 v3, v[60:63] offset:16
    v_mov_b32 v10, 0
    v_mov_b32 v11, 0
    v_mov_b32 v12, 149248
    ds_write_b64 v12, v[10:11]
    v_mov_b32 v12, 147456
    ds_write_b64 v12, v[10:11]
    s_waitcnt vmcnt(5)
    s_barrier
    s_add_u32 m0, s38, 81920
    s_add_u32 s38, s38, 16384
    buffer_load_dwordx4 v212, s[16:19], s31 offen offset:0 lds
    buffer_load_dwordx4 v213, s[16:19], s31 offen offset:1024 lds
    buffer_load_dwordx4 v214, s[16:19], s31 offen offset:2048 lds
    buffer_load_dwordx4 v215, s[16:19], s31 offen offset:3072 lds
    s_add_u32 s31, s31, 131072
    s_cmp_ge_u32 s38, s39
    s_cselect_b32 s38, s35, s38
    s_cmp_eq_u32 s31, s78
    s_cselect_b32 s31, s79, s31
    s_waitcnt lgkmcnt(0)
    s_barrier
    s_add_u32 m0, s38, 81920
    s_add_u32 s38, s38, 16384
    buffer_load_dwordx4 v212, s[16:19], s31 offen offset:0 lds
    buffer_load_dwordx4 v213, s[16:19], s31 offen offset:1024 lds
    buffer_load_dwordx4 v214, s[16:19], s31 offen offset:2048 lds
    buffer_load_dwordx4 v215, s[16:19], s31 offen offset:3072 lds
    s_add_u32 s31, s31, 131072
    s_cmp_ge_u32 s38, s39
    s_cselect_b32 s38, s35, s38
    s_cmp_eq_u32 s66, s78
    s_cselect_b32 s31, s31, s66
    s_add_u32 m0, s38, 81920
    s_add_u32 s38, s38, 16384
    buffer_load_dwordx4 v212, s[16:19], s31 offen offset:0 lds
    buffer_load_dwordx4 v213, s[16:19], s31 offen offset:1024 lds
    buffer_load_dwordx4 v214, s[16:19], s31 offen offset:2048 lds
    buffer_load_dwordx4 v215, s[16:19], s31 offen offset:3072 lds
    s_add_u32 s31, s31, 131072
    s_cmp_ge_u32 s38, s39
    s_cselect_b32 s38, s35, s38
    s_cmp_eq_u32 s31, s78
    s_cselect_b32 s31, s79, s31
    s_add_u32 m0, s35, 65536
    s_nop 0
    buffer_load_dwordx4 v208, s[12:15], s42 offen offset:0 sc1 lds
    buffer_load_dwordx4 v209, s[12:15], s42 offen offset:1024 sc1 lds
    buffer_load_dwordx4 v210, s[12:15], s42 offen offset:2048 sc1 lds
    buffer_load_dwordx4 v211, s[12:15], s42 offen offset:3072 sc1 lds
    s_add_u32 s12, s4, 0x1000000
    s_addc_u32 s13, s5, 0
    s_mov_b32 s14, 0xe00000
    s_mov_b32 s15, 0x00020000
    s_add_u32 s60, s4, 0x2800000
    s_addc_u32 s61, s5, 0
    s_mov_b32 s62, 0x23000
    s_mov_b32 s63, 0x00020000
    s_lshr_b32 s36, s34, 1
    s_lshl_b32 s36, s36, 13
    s_and_b32 s37, s34, 1
    s_lshl_b32 s37, s37, 11
    s_add_u32 s37, s37, s36
    v_lshl_add_u32 v7, v2, 4, s37
    s_lshl_b32 s36, s29, 14
    v_add_u32 v3, s36, v7
    s_cmp_eq_u32 s29, 1
    s_cselect_b32 s36, 0, 49152
    v_add_u32 v4, s36, v7
    v_lshrrev_b32 v5, 3, v2
    v_xor_b32 v5, v5, v2
    v_bfe_u32 v5, v5, 2, 1
    v_cmp_eq_u32 vcc, s29, v5
    v_mov_b32 v6, 0x80000000
    s_mul_i32 s36, s27, 7
    s_lshr_b32 s36, s36, 1
    v_cndmask_b32 v5, v6, v4, vcc
    s_mul_i32 s37, s26, 56
    s_add_u32 s36, s36, s37
    s_lshl_b32 s40, s36, 14
    s_add_u32 s41, s40, 16384
    s_add_u32 s42, s40, 32768
    s_mul_i32 s68, s54, 28
    s_add_u32 s68, s68, s37
    s_lshl_b32 s68, s68, 14
    s_add_u32 s69, s68, 458752
    s_add_u32 s30, s58, 3
    s_lshl_b32 s30, s30, 14
    s_add_u32 s30, s30, s68
    s_mov_b32 s77, s30
    s_sub_u32 s76, s30, 49152
    s_cmp_eq_u32 s68, s76
    s_cselect_b32 s30, s30, s68
    s_add_u32 s70, s29, 3
    s_and_b32 s70, s70, 3
    s_lshl_b32 s70, s70, 14
    s_add_u32 s70, s70, s35
    s_lshl_b32 s45, s55, 2
    s_add_u32 s46, s56, 0x21000
    s_add_u32 s45, s45, s46
    v_and_b32 v8, 7, v2
    v_lshlrev_b32 v8, 2, v8
    v_mov_b32 v10, 1
    s_barrier
    ds_read_b128 v[32:35], v3 offset:0
    ds_read_b128 v[36:39], v3 offset:1024
    ds_read_b128 v[40:43], v4 offset:0
    ds_read_b128 v[44:47], v4 offset:1024
    ds_read_b128 v[48:51], v3 offset:16384
    ds_read_b128 v[52:55], v3 offset:17408
    ds_read_b128 v[56:59], v3 offset:32768
    ds_read_b128 v[60:63], v3 offset:33792
    s_waitcnt lgkmcnt(7)
    buffer_store_dwordx4 v[32:35], v3, s[12:15], s40 offen offset:0 sc1
    s_waitcnt lgkmcnt(6)
    buffer_store_dwordx4 v[36:39], v3, s[12:15], s40 offen offset:1024 sc1
    s_waitcnt lgkmcnt(5)
    buffer_store_dwordx4 v[40:43], v5, s[12:15], s40 offen offset:0 sc1
    s_waitcnt lgkmcnt(4)
    buffer_store_dwordx4 v[44:47], v5, s[12:15], s40 offen offset:1024 sc1
    s_waitcnt lgkmcnt(3)
    buffer_store_dwordx4 v[48:51], v3, s[12:15], s41 offen offset:0 sc1
    s_waitcnt lgkmcnt(2)
    buffer_store_dwordx4 v[52:55], v3, s[12:15], s41 offen offset:1024 sc1
    s_waitcnt lgkmcnt(1)
    buffer_store_dwordx4 v[56:59], v3, s[12:15], s42 offen offset:0 sc1
    s_waitcnt lgkmcnt(0)
    buffer_store_dwordx4 v[60:63], v3, s[12:15], s42 offen offset:1024 sc1
    s_waitcnt vmcnt(8)
    s_barrier
    ds_read_b128 v[64:67], v3 offset:4096
    ds_read_b128 v[68:71], v3 offset:5120
    ds_read_b128 v[72:75], v4 offset:4096
    ds_read_b128 v[76:79], v4 offset:5120
    ds_read_b128 v[80:83], v3 offset:20480
    ds_read_b128 v[84:87], v3 offset:21504
    ds_read_b128 v[88:91], v3 offset:36864
    ds_read_b128 v[92:95], v3 offset:37888
    s_add_u32 s40, s40, 4096
    s_add_u32 s41, s41, 4096
    s_add_u32 s42, s42, 4096
    s_waitcnt lgkmcnt(7)
    buffer_store_dwordx4 v[64:67], v3, s[12:15], s40 offen offset:0 sc1
    s_waitcnt lgkmcnt(6)
    buffer_store_dwordx4 v[68:71], v3, s[12:15], s40 offen offset:1024 sc1
    s_waitcnt lgkmcnt(5)
    buffer_store_dwordx4 v[72:75], v5, s[12:15], s40 offen offset:0 sc1
    s_waitcnt lgkmcnt(4)
    buffer_store_dwordx4 v[76:79], v5, s[12:15], s40 offen offset:1024 sc1
    s_waitcnt lgkmcnt(3)
    buffer_store_dwordx4 v[80:83], v3, s[12:15], s41 offen offset:0 sc1
    s_waitcnt lgkmcnt(2)
    buffer_store_dwordx4 v[84:87], v3, s[12:15], s41 offen offset:1024 sc1
    s_waitcnt lgkmcnt(1)
    buffer_store_dwordx4 v[88:91], v3, s[12:15], s42 offen offset:0 sc1
    s_waitcnt lgkmcnt(0)
    buffer_store_dwordx4 v[92:95], v3, s[12:15], s42 offen offset:1024 sc1
    s_barrier
    s_barrier
    s_waitcnt vmcnt(0)
    s_mov_b64 exec, 1
    ds_add_rtn_u32 v13, v12, v10
    s_mov_b64 exec, -1
    s_waitcnt lgkmcnt(0)
    v_readfirstlane_b32 s36, v13
    s_cmp_eq_u32 s36, 3
    s_cbranch_scc0 G_wait2
    s_mov_b64 exec, 1
    buffer_store_dword v10, v11, s[60:63], s45 offen sc1
    s_mov_b64 exec, 0xff
G_poll2:
    buffer_load_dword v9, v8, s[60:63], s46 offen sc1
    s_waitcnt vmcnt(0)
    v_cmp_eq_u32 vcc, 1, v9
    s_cmp_eq_u64 vcc, exec
    s_cbranch_scc1 G_seen2
    s_sleep 4
    s_branch G_poll2
G_seen2:
    ds_write_b32 v12, v10 offset:4
    s_mov_b64 exec, -1
    s_add_u32 m0, s38, 81920
    s_add_u32 s38, s38, 16384
    buffer_load_dwordx4 v212, s[16:19], s31 offen offset:0 lds
    buffer_load_dwordx4 v213, s[16:19], s31 offen offset:1024 lds
    buffer_load_dwordx4 v214, s[16:19], s31 offen offset:2048 lds
    buffer_load_dwordx4 v215, s[16:19], s31 offen offset:3072 lds
    s_add_u32 s31, s31, 131072
    s_cmp_ge_u32 s38, s39
    s_cselect_b32 s38, s35, s38
    s_cmp_eq_u32 s31, s78
    s_cselect_b32 s31, s79, s31
    s_add_u32 m0, s38, 81920
    s_add_u32 s38, s38, 16384
    buffer_load_dwordx4 v212, s[16:19], s31 offen offset:0 lds
    buffer_load_dwordx4 v213, s[16:19], s31 offen offset:1024 lds
    buffer_load_dwordx4 v214, s[16:19], s31 offen offset:2048 lds
    buffer_load_dwordx4 v215, s[16:19], s31 offen offset:3072 lds
    s_add_u32 s31, s31, 131072
    s_cmp_ge_u32 s38, s39
    s_cselect_b32 s38, s35, s38
    s_cmp_eq_u32 s31, s78
    s_cselect_b32 s31, s79, s31
    s_branch G_go2
G_wait2:
    s_add_u32 m0, s38, 81920
    s_add_u32 s38, s38, 16384
    buffer_load_dwordx4 v212, s[16:19], s31 offen offset:0 lds
    buffer_load_dwordx4 v213, s[16:19], s31 offen offset:1024 lds
    buffer_load_dwordx4 v214, s[16:19], s31 offen offset:2048 lds
    buffer_load_dwordx4 v215, s[16:19], s31 offen offset:3072 lds
    s_add_u32 s31, s31, 131072
    s_cmp_ge_u32 s38, s39
    s_cselect_b32 s38, s35, s38
    s_cmp_eq_u32 s31, s78
    s_cselect_b32 s31, s79, s31
    s_add_u32 m0, s38, 81920
    s_add_u32 s38, s38, 16384
    buffer_load_dwordx4 v212, s[16:19], s31 offen offset:0 lds
    buffer_load_dwordx4 v213, s[16:19], s31 offen offset:1024 lds
    buffer_load_dwordx4 v214, s[16:19], s31 offen offset:2048 lds
    buffer_load_dwordx4 v215, s[16:19], s31 offen offset:3072 lds
    s_add_u32 s31, s31, 131072
    s_cmp_ge_u32 s38, s39
    s_cselect_b32 s38, s35, s38
    s_cmp_eq_u32 s31, s78
    s_cselect_b32 s31, s79, s31
G_spin2:
    s_sleep 1
    ds_read_b32 v13, v12 offset:4
    s_waitcnt lgkmcnt(0)
    v_readfirstlane_b32 s36, v13
    s_cmp_eq_u32 s36, 1
    s_cbranch_scc0 G_spin2
G_go2:
    s_mov_b32 m0, s70
    s_add_u32 s70, s70, 16384
    buffer_load_dwordx4 v224, s[12:15], s30 offen offset:0 sc1 lds
    buffer_load_dwordx4 v224, s[12:15], s30 offen offset:1024 sc1 lds
    buffer_load_dwordx4 v224, s[12:15], s30 offen offset:2048 sc1 lds
    buffer_load_dwordx4 v224, s[12:15], s30 offen offset:3072 sc1 lds
    s_add_u32 s30, s30, 16384
    s_cmp_ge_u32 s70, s39
    s_cselect_b32 s70, s35, s70
    s_cmp_eq_u32 s30, s76
    s_cselect_b32 s30, s77, s30
    s_mov_b32 m0, s70
    s_add_u32 s70, s70, 16384
    buffer_load_dwordx4 v224, s[12:15], s30 offen offset:0 sc1 lds
    buffer_load_dwordx4 v224, s[12:15], s30 offen offset:1024 sc1 lds
    buffer_load_dwordx4 v224, s[12:15], s30 offen offset:2048 sc1 lds
    buffer_load_dwordx4 v224, s[12:15], s30 offen offset:3072 sc1 lds
    s_add_u32 s30, s30, 16384
    s_cmp_ge_u32 s70, s39
    s_cselect_b32 s70, s35, s70
    s_cmp_eq_u32 s30, s76
    s_cselect_b32 s30, s77, s30
    s_waitcnt vmcnt(4)
    s_barrier
    s_mov_b32 m0, s70
    s_add_u32 s70, s70, 16384
    buffer_load_dwordx4 v224, s[12:15], s30 offen offset:0 sc1 lds
    buffer_load_dwordx4 v224, s[12:15], s30 offen offset:1024 sc1 lds
    buffer_load_dwordx4 v224, s[12:15], s30 offen offset:2048 sc1 lds
    buffer_load_dwordx4 v224, s[12:15], s30 offen offset:3072 sc1 lds
    s_add_u32 s30, s30, 16384
    s_cmp_ge_u32 s70, s39
    s_cselect_b32 s70, s35, s70
    s_cmp_eq_u32 s30, s76
    s_cselect_b32 s30, s77, s30
    s_mov_b32 m0, s70
    s_add_u32 s70, s70, 16384
    buffer_load_dwordx4 v224, s[12:15], s30 offen offset:0 sc1 lds
    buffer_load_dwordx4 v224, s[12:15], s30 offen offset:1024 sc1 lds
    buffer_load_dwordx4 v224, s[12:15], s30 offen offset:2048 sc1 lds
    buffer_load_dwordx4 v224, s[12:15], s30 offen offset:3072 sc1 lds
    s_add_u32 s30, s30, 16384
    s_cmp_ge_u32 s70, s39
    s_cselect_b32 s70, s35, s70
    s_cmp_eq_u32 s30, s76
    s_cselect_b32 s30, s77, s30
    s_add_u32 m0, s38, 81920
    s_add_u32 s38, s38, 16384
    buffer_load_dwordx4 v212, s[16:19], s31 offen offset:0 lds
    buffer_load_dwordx4 v213, s[16:19], s31 offen offset:1024 lds
    buffer_load_dwordx4 v214, s[16:19], s31 offen offset:2048 lds
    buffer_load_dwordx4 v215, s[16:19], s31 offen offset:3072 lds
    s_add_u32 s31, s31, 131072
    s_cmp_ge_u32 s38, s39
    s_cselect_b32 s38, s35, s38
    s_cmp_eq_u32 s31, s78
    s_cselect_b32 s31, s79, s31
    s_waitcnt vmcnt(12)
    s_barrier
    s_mov_b32 m0, s70
    s_add_u32 s70, s70, 16384
    buffer_load_dwordx4 v224, s[12:15], s30 offen offset:0 sc1 lds
    buffer_load_dwordx4 v224, s[12:15], s30 offen offset:1024 sc1 lds
    buffer_load_dwordx4 v224, s[12:15], s30 offen offset:2048 sc1 lds
    buffer_load_dwordx4 v224, s[12:15], s30 offen offset:3072 sc1 lds
    s_add_u32 s30, s30, 16384
    s_cmp_ge_u32 s70, s39
    s_cselect_b32 s70, s35, s70
    s_cmp_eq_u32 s30, s76
    s_cselect_b32 s30, s77, s30
    s_add_u32 m0, s38, 81920
    s_add_u32 s38, s38, 16384
    buffer_load_dwordx4 v212, s[16:19], s31 offen offset:0 lds
    buffer_load_dwordx4 v213, s[16:19], s31 offen offset:1024 lds
    buffer_load_dwordx4 v214, s[16:19], s31 offen offset:2048 lds
    buffer_load_dwordx4 v215, s[16:19], s31 offen offset:3072 lds
    s_add_u32 s31, s31, 131072
    s_cmp_ge_u32 s38, s39
    s_cselect_b32 s38, s35, s38
    s_cmp_eq_u32 s31, s78
    s_cselect_b32 s31, s79, s31
    s_branch G_nochk2
G_chk2:
G_nochk2:
    s_mov_b32 s40, 4
G_l2:
    s_waitcnt vmcnt(16)
    s_barrier
    s_mov_b32 m0, s70
    s_add_u32 s70, s70, 16384
    buffer_load_dwordx4 v224, s[12:15], s30 offen offset:0 sc1 lds
    buffer_load_dwordx4 v224, s[12:15], s30 offen offset:1024 sc1 lds
    buffer_load_dwordx4 v224, s[12:15], s30 offen offset:2048 sc1 lds
    buffer_load_dwordx4 v224, s[12:15], s30 offen offset:3072 sc1 lds
    s_add_u32 s30, s30, 16384
    s_cmp_ge_u32 s70, s39
    s_cselect_b32 s70, s35, s70
    s_cmp_eq_u32 s30, s76
    s_cselect_b32 s30, s77, s30
    s_add_u32 m0, s38, 81920
    s_add_u32 s38, s38, 16384
    buffer_load_dwordx4 v212, s[16:19], s31 offen offset:0 lds
    buffer_load_dwordx4 v213, s[16:19], s31 offen offset:1024 lds
    buffer_load_dwordx4 v214, s[16:19], s31 offen offset:2048 lds
    buffer_load_dwordx4 v215, s[16:19], s31 offen offset:3072 lds
    s_add_u32 s31, s31, 131072
    s_cmp_ge_u32 s38, s39
    s_cselect_b32 s38, s35, s38
    s_cmp_eq_u32 s31, s78
    s_cselect_b32 s31, s79, s31
    s_add_u32 s40, s40, 1
    s_cmp_lt_u32 s40, 24
    s_cbranch_scc1 G_l2
    s_waitcnt vmcnt(16)
    s_barrier
    s_waitcnt vmcnt(8)
    s_barrier
    s_waitcnt vmcnt(0)
    s_barrier
    s_barrier
    s_branch G_epi2
G_cons:
    v_mov_b32 v240, v2
    v_and_b32 v241, 15, v2
    v_lshrrev_b32 v242, 4, v2
    v_lshlrev_b32 v243, 3, v242
    s_and_b32 s34, s33, 1
    s_lshr_b32 s35, s33, 1
    s_lshl_b32 s36, s34, 13
    v_lshl_add_u32 v244, v241, 7, s36
    v_and_b32 v245, 7, v241
    v_bfe_u32 v246, v240, 2, 2
    v_lshl_add_u32 v247, v242, 3, v246
    v_and_b32 v248, 3, v240
    v_lshlrev_b32 v248, 3, v248
    v_lshl_add_u32 v249, v247, 8, v248
    v_lshl_add_u32 v247, v247, 9, v248
    v_add_u32 v247, 49152, v247
    v_and_b32 v248, 1, v242
    v_lshl_or_b32 v246, v248, 2, v246
    s_lshl_b32 s37, s34, 2
    s_add_u32 s38, s37, 0
    v_xor_b32 v248, s38, v246
    v_lshl_add_u32 v200, v248, 5, v249
    s_add_u32 s38, s37, 1
    v_xor_b32 v248, s38, v246
    v_lshl_add_u32 v201, v248, 5, v249
    s_add_u32 s38, s37, 2
    v_xor_b32 v248, s38, v246
    v_lshl_add_u32 v202, v248, 5, v249
    s_add_u32 s38, s37, 3
    v_xor_b32 v248, s38, v246
    v_lshl_add_u32 v203, v248, 5, v249
    s_mul_i32 s37, s35, 7
    s_lshl_b32 s38, s29, 1
    s_add_u32 s37, s37, s38
    s_add_u32 s38, s37, 0
    v_xor_b32 v248, s38, v246
    v_lshl_add_u32 v204, v248, 5, v247
    v_add_u32 v235, 0x10000, v204
    s_add_u32 s38, s37, 1
    v_xor_b32 v248, s38, v246
    v_lshl_add_u32 v205, v248, 5, v247
    v_add_u32 v236, 0x10000, v205
    s_add_u32 s38, s37, 2
    v_xor_b32 v248, s38, v246
    v_lshl_add_u32 v206, v248, 5, v247
    v_add_u32 v237, 0x10000, v206
    s_add_u32 s38, s37, 3
    v_xor_b32 v248, s38, v246
    v_lshl_add_u32 v207, v248, 5, v247
    v_add_u32 v238, 0x10000, v207
    s_add_u32 s38, s37, 4
    v_xor_b32 v248, s38, v246
    v_lshl_add_u32 v208, v248, 5, v247
    v_add_u32 v239, 0x10000, v208
    s_add_u32 s38, s37, 5
    v_xor_b32 v248, s38, v246
    v_lshl_add_u32 v209, v248, 5, v247
    v_add_u32 v211, 0x10000, v209
    s_add_u32 s38, s37, 6
    v_xor_b32 v248, s38, v246
    v_lshl_add_u32 v210, v248, 5, v247
    v_add_u32 v232, 0x10000, v210
    v_mov_b64 v[0:1], 0
    v_mov_b64 v[2:3], 0
    v_mov_b64 v[4:5], 0
    v_mov_b64 v[6:7], 0
    v_mov_b64 v[8:9], 0
    v_mov_b64 v[10:11], 0
    v_mov_b64 v[12:13], 0
    v_mov_b64 v[14:15], 0
    v_mov_b64 v[16:17], 0
    v_mov_b64 v[18:19], 0
    v_mov_b64 v[20:21], 0
    v_mov_b64 v[22:23], 0
    v_mov_b64 v[24:25], 0
    v_mov_b64 v[26:27], 0
    v_mov_b64 v[28:29], 0
    v_mov_b64 v[30:31], 0
    v_mov_b64 v[32:33], 0
    v_mov_b64 v[34:35], 0
    v_mov_b64 v[36:37], 0
    v_mov_b64 v[38:39], 0
    v_mov_b64 v[40:41], 0
    v_mov_b64 v[42:43], 0
    v_mov_b64 v[44:45], 0
    v_mov_b64 v[46:47], 0
    v_mov_b64 v[48:49], 0
    v_mov_b64 v[50:51], 0
    v_mov_b64 v[52:53], 0
    v_mov_b64 v[54:55], 0
    v_mov_b64 v[56:57], 0
    v_mov_b64 v[58:59], 0
    v_mov_b64 v[60:61], 0
    v_mov_b64 v[62:63], 0
    v_mov_b64 v[64:65], 0
    v_mov_b64 v[66:67], 0
    v_mov_b64 v[68:69], 0
    v_mov_b64 v[70:71], 0
    v_mov_b64 v[72:73], 0
    v_mov_b64 v[74:75], 0
    v_mov_b64 v[76:77], 0
    v_mov_b64 v[78:79], 0
    v_mov_b64 v[80:81], 0
    v_mov_b64 v[82:83], 0
    v_mov_b64 v[84:85], 0
    v_mov_b64 v[86:87], 0
    v_mov_b64 v[88:89], 0
    v_mov_b64 v[90:91], 0
    v_mov_b64 v[92:93], 0
    v_mov_b64 v[94:95], 0
    v_mov_b64 v[96:97], 0
    v_mov_b64 v[98:99], 0
    v_mov_b64 v[100:101], 0
    v_mov_b64 v[102:103], 0
    v_mov_b64 v[104:105], 0
    v_mov_b64 v[106:107], 0
    v_mov_b64 v[108:109], 0
    v_mov_b64 v[110:111], 0
    v_mov_b32 v228, 0x3f803f80
    v_mov_b32 v229, 0x3f803f80
    v_mov_b32 v230, 0x3f803f80
    v_mov_b32 v231, 0x3f803f80
    v_lshrrev_b32 v248, 2, v241
    v_and_b32 v249, 3, v240
    v_cmp_eq_u32 s[70:71], v248, v242
    v_cmp_eq_u32 s[64:65], 1, v249
    v_cmp_eq_u32 s[66:67], 2, v249
    v_cmp_eq_u32 s[68:69], 3, v249
    s_and_b32 s41, s27, 3
    s_add_u32 s41, s41, 1
    s_lshl_b32 s59, s26, 14
    s_xor_b32 s36, s35, 1
    s_lshl_b32 s36, s36, 13
    s_add_u32 s59, s59, s36
    s_lshl_b32 s36, s27, 9
    s_add_u32 s59, s59, s36
    s_lshl_b32 s36, s34, 8
    s_add_u32 s59, s59, s36
    s_mul_i32 s36, s35, 896
    s_add_u32 s36, s36, 149312
    v_lshl_add_u32 v233, v241, 3, s36
    s_lshl_b32 s36, s34, 9
    s_add_u32 s36, s36, 148224
    v_lshl_add_u32 v247, v241, 3, s36
    v_cmp_eq_u32 vcc, 0, v242
    v_mov_b32 v248, 149248
    v_mov_b32 v249, 128
    v_cndmask_b32 v252, v248, v247, vcc
    v_cndmask_b32 v249, 0, v249, vcc
    v_add_u32 v253, v252, v249
    v_add_u32 v254, v253, v249
    v_add_u32 v255, v254, v249
    v_lshrrev_b32 v246, 1, v242
    v_xor_b32 v246, v246, v245
    v_lshlrev_b32 v246, 4, v246
    v_and_b32 v247, 1, v242
    v_lshl_add_u32 v247, v247, 3, v244
    s_add_u32 s38, s37, 0
    s_lshr_b32 s39, s38, 2
    s_lshl_b32 s39, s39, 14
    s_and_b32 s38, s38, 3
    s_lshl_b32 s38, s38, 5
    s_or_b32 s76, s38, s39
    s_add_u32 s38, s37, 1
    s_lshr_b32 s39, s38, 2
    s_lshl_b32 s39, s39, 14
    s_and_b32 s38, s38, 3
    s_lshl_b32 s38, s38, 5
    s_or_b32 s77, s38, s39
    s_add_u32 s38, s37, 2
    s_lshr_b32 s39, s38, 2
    s_lshl_b32 s39, s39, 14
    s_and_b32 s38, s38, 3
    s_lshl_b32 s38, s38, 5
    s_or_b32 s78, s38, s39
    s_add_u32 s38, s37, 3
    s_lshr_b32 s39, s38, 2
    s_lshl_b32 s39, s39, 14
    s_and_b32 s38, s38, 3
    s_lshl_b32 s38, s38, 5
    s_or_b32 s79, s38, s39
    s_add_u32 s38, s37, 4
    s_lshr_b32 s39, s38, 2
    s_lshl_b32 s39, s39, 14
    s_and_b32 s38, s38, 3
    s_lshl_b32 s38, s38, 5
    s_or_b32 s60, s38, s39
    s_add_u32 s38, s37, 5
    s_lshr_b32 s39, s38, 2
    s_lshl_b32 s39, s39, 14
    s_and_b32 s38, s38, 3
    s_lshl_b32 s38, s38, 5
    s_or_b32 s61, s38, s39
    s_add_u32 s38, s37, 6
    s_lshr_b32 s39, s38, 2
    s_lshl_b32 s39, s39, 14
    s_and_b32 s38, s38, 3
    s_lshl_b32 s38, s38, 5
    s_or_b32 s62, s38, s39
    s_waitcnt lgkmcnt(0)
    s_add_u32 s72, s4, 0xc80000
    s_addc_u32 s73, s5, 0
    s_mov_b32 s74, 0x40000
    s_mov_b32 s75, 0x00020000
    s_barrier
    s_mov_b32 s40, 0
    ds_read_b64_tr_b16 v[112:113], v200 offset:0
    ds_read_b64_tr_b16 v[114:115], v200 offset:1024
    ds_read_b64_tr_b16 v[116:117], v201 offset:0
    ds_read_b64_tr_b16 v[118:119], v201 offset:1024
    ds_read_b64_tr_b16 v[120:121], v202 offset:0
    ds_read_b64_tr_b16 v[122:123], v202 offset:1024
    ds_read_b64_tr_b16 v[124:125], v203 offset:0
    ds_read_b64_tr_b16 v[126:127], v203 offset:1024
    ds_read_b64_tr_b16 v[128:129], v204 offset:0
    ds_read_b64_tr_b16 v[130:131], v204 offset:2048
    ds_read_b64_tr_b16 v[132:133], v205 offset:0
    ds_read_b64_tr_b16 v[134:135], v205 offset:2048
    ds_read_b64_tr_b16 v[136:137], v206 offset:0
    ds_read_b64_tr_b16 v[138:139], v206 offset:2048
    ds_read_b64_tr_b16 v[140:141], v207 offset:0
    ds_read_b64_tr_b16 v[142:143], v207 offset:2048
    ds_read_b64_tr_b16 v[144:145], v208 offset:0
    ds_read_b64_tr_b16 v[146:147], v208 offset:2048
    ds_read_b64_tr_b16 v[148:149], v209 offset:0
    ds_read_b64_tr_b16 v[150:151], v209 offset:2048
    ds_read_b64_tr_b16 v[152:153], v210 offset:0
    ds_read_b64_tr_b16 v[154:155], v210 offset:2048
G1_s0:
    s_waitcnt lgkmcnt(12)
    v_mfma_f32_16x16x32_bf16 v[0:3], v[128:131], v[112:115], v[0:3]
    ds_read_b64_tr_b16 v[156:157], v200 offset:8192
    v_mfma_f32_16x16x32_bf16 v[28:31], v[128:131], v[116:119], v[28:31]
    ds_read_b64_tr_b16 v[158:159], v200 offset:9216
    v_mfma_f32_16x16x32_bf16 v[56:59], v[128:131], v[120:123], v[56:59]
    ds_read_b64_tr_b16 v[160:161], v201 offset:8192
    v_mfma_f32_16x16x32_bf16 v[84:87], v[128:131], v[124:127], v[84:87]
    ds_read_b64_tr_b16 v[162:163], v201 offset:9216
    s_waitcnt lgkmcnt(14)
    v_mfma_f32_16x16x32_bf16 v[4:7], v[132:135], v[112:115], v[4:7]
    ds_read_b64_tr_b16 v[164:165], v202 offset:8192
    v_mfma_f32_16x16x32_bf16 v[32:35], v[132:135], v[116:119], v[32:35]
    ds_read_b64_tr_b16 v[166:167], v202 offset:9216
    v_mfma_f32_16x16x32_bf16 v[60:63], v[132:135], v[120:123], v[60:63]
    ds_read_b64_tr_b16 v[168:169], v203 offset:8192
    v_mfma_f32_16x16x32_bf16 v[88:91], v[132:135], v[124:127], v[88:91]
    ds_read_b64_tr_b16 v[170:171], v203 offset:9216
    s_waitcnt lgkmcnt(15)
    v_mfma_f32_16x16x32_bf16 v[8:11], v[136:139], v[112:115], v[8:11]
    ds_read_b64_tr_b16 v[172:173], v204 offset:16384
    v_mfma_f32_16x16x32_bf16 v[36:39], v[136:139], v[116:119], v[36:39]
    ds_read_b64_tr_b16 v[174:175], v204 offset:18432
    v_mfma_f32_16x16x32_bf16 v[64:67], v[136:139], v[120:123], v[64:67]
    ds_read_b64_tr_b16 v[176:177], v205 offset:16384
    v_mfma_f32_16x16x32_bf16 v[92:95], v[136:139], v[124:127], v[92:95]
    ds_read_b64_tr_b16 v[178:179], v205 offset:18432
    s_waitcnt lgkmcnt(15)
    v_mfma_f32_16x16x32_bf16 v[12:15], v[140:143], v[112:115], v[12:15]
    ds_read_b64_tr_b16 v[180:181], v206 offset:16384
    v_mfma_f32_16x16x32_bf16 v[40:43], v[140:143], v[116:119], v[40:43]
    ds_read_b64_tr_b16 v[182:183], v206 offset:18432
    v_mfma_f32_16x16x32_bf16 v[68:71], v[140:143], v[120:123], v[68:71]
    ds_read_b64_tr_b16 v[184:185], v207 offset:16384
    v_mfma_f32_16x16x32_bf16 v[96:99], v[140:143], v[124:127], v[96:99]
    ds_read_b64_tr_b16 v[186:187], v207 offset:18432
    s_waitcnt lgkmcnt(15)
    v_mfma_f32_16x16x32_bf16 v[16:19], v[144:147], v[112:115], v[16:19]
    ds_read_b64_tr_b16 v[188:189], v208 offset:16384
    v_mfma_f32_16x16x32_bf16 v[44:47], v[144:147], v[116:119], v[44:47]
    ds_read_b64_tr_b16 v[190:191], v208 offset:18432
    v_mfma_f32_16x16x32_bf16 v[72:75], v[144:147], v[120:123], v[72:75]
    ds_read_b64_tr_b16 v[192:193], v209 offset:16384
    v_mfma_f32_16x16x32_bf16 v[100:103], v[144:147], v[124:127], v[100:103]
    ds_read_b64_tr_b16 v[194:195], v209 offset:18432
    s_waitcnt lgkmcnt(15)
    v_mfma_f32_16x16x32_bf16 v[20:23], v[148:151], v[112:115], v[20:23]
    ds_read_b64_tr_b16 v[196:197], v210 offset:16384
    v_mfma_f32_16x16x32_bf16 v[48:51], v[148:151], v[116:119], v[48:51]
    ds_read_b64_tr_b16 v[198:199], v210 offset:18432
    v_mfma_f32_16x16x32_bf16 v[76:79], v[148:151], v[120:123], v[76:79]
    v_mfma_f32_16x16x32_bf16 v[104:107], v[148:151], v[124:127], v[104:107]
    s_waitcnt lgkmcnt(15)
    v_mfma_f32_16x16x32_bf16 v[24:27], v[152:155], v[112:115], v[24:27]
    v_mfma_f32_16x16x32_bf16 v[52:55], v[152:155], v[116:119], v[52:55]
    s_add_u32 s40, s40, 1
    v_mfma_f32_16x16x32_bf16 v[80:83], v[152:155], v[120:123], v[80:83]
    s_cmp_eq_u32 s40, 16
    v_mfma_f32_16x16x32_bf16 v[108:111], v[152:155], v[124:127], v[108:111]
    s_waitcnt lgkmcnt(0)
    s_barrier
    s_cbranch_scc1 G1_tail
    s_cmp_eq_u32 s40, s41
    s_cbranch_scc1 G_xa0
G_xar0:
    v_mfma_f32_16x16x32_bf16 v[0:3], v[172:175], v[156:159], v[0:3]
    ds_read_b64_tr_b16 v[112:113], v200 offset:16384
    v_mfma_f32_16x16x32_bf16 v[28:31], v[172:175], v[160:163], v[28:31]
    ds_read_b64_tr_b16 v[114:115], v200 offset:17408
    v_mfma_f32_16x16x32_bf16 v[56:59], v[172:175], v[164:167], v[56:59]
    ds_read_b64_tr_b16 v[116:117], v201 offset:16384
    v_mfma_f32_16x16x32_bf16 v[84:87], v[172:175], v[168:171], v[84:87]
    ds_read_b64_tr_b16 v[118:119], v201 offset:17408
    v_mfma_f32_16x16x32_bf16 v[4:7], v[176:179], v[156:159], v[4:7]
    ds_read_b64_tr_b16 v[120:121], v202 offset:16384
    v_mfma_f32_16x16x32_bf16 v[32:35], v[176:179], v[160:163], v[32:35]
    ds_read_b64_tr_b16 v[122:123], v202 offset:17408
    v_mfma_f32_16x16x32_bf16 v[60:63], v[176:179], v[164:167], v[60:63]
    ds_read_b64_tr_b16 v[124:125], v203 offset:16384
    v_mfma_f32_16x16x32_bf16 v[88:91], v[176:179], v[168:171], v[88:91]
    ds_read_b64_tr_b16 v[126:127], v203 offset:17408
    v_mfma_f32_16x16x32_bf16 v[8:11], v[180:183], v[156:159], v[8:11]
    ds_read_b64_tr_b16 v[128:129], v204 offset:32768
    v_mfma_f32_16x16x32_bf16 v[36:39], v[180:183], v[160:163], v[36:39]
    ds_read_b64_tr_b16 v[130:131], v204 offset:34816
    v_mfma_f32_16x16x32_bf16 v[64:67], v[180:183], v[164:167], v[64:67]
    ds_read_b64_tr_b16 v[132:133], v205 offset:32768
    v_mfma_f32_16x16x32_bf16 v[92:95], v[180:183], v[168:171], v[92:95]
    ds_read_b64_tr_b16 v[134:135], v205 offset:34816
    v_mfma_f32_16x16x32_bf16 v[12:15], v[184:187], v[156:159], v[12:15]
    ds_read_b64_tr_b16 v[136:137], v206 offset:32768
    v_mfma_f32_16x16x32_bf16 v[40:43], v[184:187], v[160:163], v[40:43]
    ds_read_b64_tr_b16 v[138:139], v206 offset:34816
    v_mfma_f32_16x16x32_bf16 v[68:71], v[184:187], v[164:167], v[68:71]
    ds_read_b64_tr_b16 v[140:141], v207 offset:32768
    v_mfma_f32_16x16x32_bf16 v[96:99], v[184:187], v[168:171], v[96:99]
    ds_read_b64_tr_b16 v[142:143], v207 offset:34816
    v_mfma_f32_16x16x32_bf16 v[16:19], v[188:191], v[156:159], v[16:19]
    ds_read_b64_tr_b16 v[144:145], v208 offset:32768
    v_mfma_f32_16x16x32_bf16 v[44:47], v[188:191], v[160:163], v[44:47]
    ds_read_b64_tr_b16 v[146:147], v208 offset:34816
    v_mfma_f32_16x16x32_bf16 v[72:75], v[188:191], v[164:167], v[72:75]
    ds_read_b64_tr_b16 v[148:149], v209 offset:32768
    v_mfma_f32_16x16x32_bf16 v[100:103], v[188:191], v[168:171], v[100:103]
    ds_read_b64_tr_b16 v[150:151], v209 offset:34816
    v_mfma_f32_16x16x32_bf16 v[20:23], v[192:195], v[156:159], v[20:23]
    ds_read_b64_tr_b16 v[152:153], v210 offset:32768
    v_mfma_f32_16x16x32_bf16 v[48:51], v[192:195], v[160:163], v[48:51]
    ds_read_b64_tr_b16 v[154:155], v210 offset:34816
    v_mfma_f32_16x16x32_bf16 v[76:79], v[192:195], v[164:167], v[76:79]
    v_mfma_f32_16x16x32_bf16 v[104:107], v[192:195], v[168:171], v[104:107]
    v_mfma_f32_16x16x32_bf16 v[24:27], v[196:199], v[156:159], v[24:27]
    v_mfma_f32_16x16x32_bf16 v[52:55], v[196:199], v[160:163], v[52:55]
    v_mfma_f32_16x16x32_bf16 v[80:83], v[196:199], v[164:167], v[80:83]
    v_mfma_f32_16x16x32_bf16 v[108:111], v[196:199], v[168:171], v[108:111]
    s_cmp_eq_u32 s40, s41
    s_cbranch_scc1 G_xb
G1_s1:
    s_waitcnt lgkmcnt(12)
    v_mfma_f32_16x16x32_bf16 v[0:3], v[128:131], v[112:115], v[0:3]
    ds_read_b64_tr_b16 v[156:157], v200 offset:24576
    v_mfma_f32_16x16x32_bf16 v[28:31], v[128:131], v[116:119], v[28:31]
    ds_read_b64_tr_b16 v[158:159], v200 offset:25600
    v_mfma_f32_16x16x32_bf16 v[56:59], v[128:131], v[120:123], v[56:59]
    ds_read_b64_tr_b16 v[160:161], v201 offset:24576
    v_mfma_f32_16x16x32_bf16 v[84:87], v[128:131], v[124:127], v[84:87]
    ds_read_b64_tr_b16 v[162:163], v201 offset:25600
    s_waitcnt lgkmcnt(14)
    v_mfma_f32_16x16x32_bf16 v[4:7], v[132:135], v[112:115], v[4:7]
    ds_read_b64_tr_b16 v[164:165], v202 offset:24576
    v_mfma_f32_16x16x32_bf16 v[32:35], v[132:135], v[116:119], v[32:35]
    ds_read_b64_tr_b16 v[166:167], v202 offset:25600
    v_mfma_f32_16x16x32_bf16 v[60:63], v[132:135], v[120:123], v[60:63]
    ds_read_b64_tr_b16 v[168:169], v203 offset:24576
    v_mfma_f32_16x16x32_bf16 v[88:91], v[132:135], v[124:127], v[88:91]
    ds_read_b64_tr_b16 v[170:171], v203 offset:25600
    s_waitcnt lgkmcnt(15)
    v_mfma_f32_16x16x32_bf16 v[8:11], v[136:139], v[112:115], v[8:11]
    ds_read_b64_tr_b16 v[172:173], v204 offset:49152
    v_mfma_f32_16x16x32_bf16 v[36:39], v[136:139], v[116:119], v[36:39]
    ds_read_b64_tr_b16 v[174:175], v204 offset:51200
    v_mfma_f32_16x16x32_bf16 v[64:67], v[136:139], v[120:123], v[64:67]
    ds_read_b64_tr_b16 v[176:177], v205 offset:49152
    v_mfma_f32_16x16x32_bf16 v[92:95], v[136:139], v[124:127], v[92:95]
    ds_read_b64_tr_b16 v[178:179], v205 offset:51200
    s_waitcnt lgkmcnt(15)
    v_mfma_f32_16x16x32_bf16 v[12:15], v[140:143], v[112:115], v[12:15]
    ds_read_b64_tr_b16 v[180:181], v206 offset:49152
    v_mfma_f32_16x16x32_bf16 v[40:43], v[140:143], v[116:119], v[40:43]
    ds_read_b64_tr_b16 v[182:183], v206 offset:51200
    v_mfma_f32_16x16x32_bf16 v[68:71], v[140:143], v[120:123], v[68:71]
    ds_read_b64_tr_b16 v[184:185], v207 offset:49152
    v_mfma_f32_16x16x32_bf16 v[96:99], v[140:143], v[124:127], v[96:99]
    ds_read_b64_tr_b16 v[186:187], v207 offset:51200
    s_waitcnt lgkmcnt(15)
    v_mfma_f32_16x16x32_bf16 v[16:19], v[144:147], v[112:115], v[16:19]
    ds_read_b64_tr_b16 v[188:189], v208 offset:49152
    v_mfma_f32_16x16x32_bf16 v[44:47], v[144:147], v[116:119], v[44:47]
    ds_read_b64_tr_b16 v[190:191], v208 offset:51200
    v_mfma_f32_16x16x32_bf16 v[72:75], v[144:147], v[120:123], v[72:75]
    ds_read_b64_tr_b16 v[192:193], v209 offset:49152
    v_mfma_f32_16x16x32_bf16 v[100:103], v[144:147], v[124:127], v[100:103]
    ds_read_b64_tr_b16 v[194:195], v209 offset:51200
    s_waitcnt lgkmcnt(15)
    v_mfma_f32_16x16x32_bf16 v[20:23], v[148:151], v[112:115], v[20:23]
    ds_read_b64_tr_b16 v[196:197], v210 offset:49152
    v_mfma_f32_16x16x32_bf16 v[48:51], v[148:151], v[116:119], v[48:51]
    ds_read_b64_tr_b16 v[198:199], v210 offset:51200
    v_mfma_f32_16x16x32_bf16 v[76:79], v[148:151], v[120:123], v[76:79]
    v_mfma_f32_16x16x32_bf16 v[104:107], v[148:151], v[124:127], v[104:107]
    s_waitcnt lgkmcnt(15)
    v_mfma_f32_16x16x32_bf16 v[24:27], v[152:155], v[112:115], v[24:27]
    v_mfma_f32_16x16x32_bf16 v[52:55], v[152:155], v[116:119], v[52:55]
    s_add_u32 s40, s40, 1
    v_mfma_f32_16x16x32_bf16 v[80:83], v[152:155], v[120:123], v[80:83]
    s_cmp_eq_u32 s40, 16
    v_mfma_f32_16x16x32_bf16 v[108:111], v[152:155], v[124:127], v[108:111]
    s_waitcnt lgkmcnt(0)
    s_barrier
    s_cbranch_scc1 G1_tail
    s_cmp_eq_u32 s40, s41
    s_cbranch_scc1 G_xa1
G_xar1:
    v_mfma_f32_16x16x32_bf16 v[0:3], v[172:175], v[156:159], v[0:3]
    ds_read_b64_tr_b16 v[112:113], v200 offset:32768
    v_mfma_f32_16x16x32_bf16 v[28:31], v[172:175], v[160:163], v[28:31]
    ds_read_b64_tr_b16 v[114:115], v200 offset:33792
    v_mfma_f32_16x16x32_bf16 v[56:59], v[172:175], v[164:167], v[56:59]
    ds_read_b64_tr_b16 v[116:117], v201 offset:32768
    v_mfma_f32_16x16x32_bf16 v[84:87], v[172:175], v[168:171], v[84:87]
    ds_read_b64_tr_b16 v[118:119], v201 offset:33792
    v_mfma_f32_16x16x32_bf16 v[4:7], v[176:179], v[156:159], v[4:7]
    ds_read_b64_tr_b16 v[120:121], v202 offset:32768
    v_mfma_f32_16x16x32_bf16 v[32:35], v[176:179], v[160:163], v[32:35]
    ds_read_b64_tr_b16 v[122:123], v202 offset:33792
    v_mfma_f32_16x16x32_bf16 v[60:63], v[176:179], v[164:167], v[60:63]
    ds_read_b64_tr_b16 v[124:125], v203 offset:32768
    v_mfma_f32_16x16x32_bf16 v[88:91], v[176:179], v[168:171], v[88:91]
    ds_read_b64_tr_b16 v[126:127], v203 offset:33792
    v_mfma_f32_16x16x32_bf16 v[8:11], v[180:183], v[156:159], v[8:11]
    ds_read_b64_tr_b16 v[128:129], v235 offset:0
    v_mfma_f32_16x16x32_bf16 v[36:39], v[180:183], v[160:163], v[36:39]
    ds_read_b64_tr_b16 v[130:131], v235 offset:2048
    v_mfma_f32_16x16x32_bf16 v[64:67], v[180:183], v[164:167], v[64:67]
    ds_read_b64_tr_b16 v[132:133], v236 offset:0
    v_mfma_f32_16x16x32_bf16 v[92:95], v[180:183], v[168:171], v[92:95]
    ds_read_b64_tr_b16 v[134:135], v236 offset:2048
    v_mfma_f32_16x16x32_bf16 v[12:15], v[184:187], v[156:159], v[12:15]
    ds_read_b64_tr_b16 v[136:137], v237 offset:0
    v_mfma_f32_16x16x32_bf16 v[40:43], v[184:187], v[160:163], v[40:43]
    ds_read_b64_tr_b16 v[138:139], v237 offset:2048
    v_mfma_f32_16x16x32_bf16 v[68:71], v[184:187], v[164:167], v[68:71]
    ds_read_b64_tr_b16 v[140:141], v238 offset:0
    v_mfma_f32_16x16x32_bf16 v[96:99], v[184:187], v[168:171], v[96:99]
    ds_read_b64_tr_b16 v[142:143], v238 offset:2048
    v_mfma_f32_16x16x32_bf16 v[16:19], v[188:191], v[156:159], v[16:19]
    ds_read_b64_tr_b16 v[144:145], v239 offset:0
    v_mfma_f32_16x16x32_bf16 v[44:47], v[188:191], v[160:163], v[44:47]
    ds_read_b64_tr_b16 v[146:147], v239 offset:2048
    v_mfma_f32_16x16x32_bf16 v[72:75], v[188:191], v[164:167], v[72:75]
    ds_read_b64_tr_b16 v[148:149], v211 offset:0
    v_mfma_f32_16x16x32_bf16 v[100:103], v[188:191], v[168:171], v[100:103]
    ds_read_b64_tr_b16 v[150:151], v211 offset:2048
    v_mfma_f32_16x16x32_bf16 v[20:23], v[192:195], v[156:159], v[20:23]
    ds_read_b64_tr_b16 v[152:153], v232 offset:0
    v_mfma_f32_16x16x32_bf16 v[48:51], v[192:195], v[160:163], v[48:51]
    ds_read_b64_tr_b16 v[154:155], v232 offset:2048
    v_mfma_f32_16x16x32_bf16 v[76:79], v[192:195], v[164:167], v[76:79]
    v_mfma_f32_16x16x32_bf16 v[104:107], v[192:195], v[168:171], v[104:107]
    v_mfma_f32_16x16x32_bf16 v[24:27], v[196:199], v[156:159], v[24:27]
    v_mfma_f32_16x16x32_bf16 v[52:55], v[196:199], v[160:163], v[52:55]
    v_mfma_f32_16x16x32_bf16 v[80:83], v[196:199], v[164:167], v[80:83]
    v_mfma_f32_16x16x32_bf16 v[108:111], v[196:199], v[168:171], v[108:111]
    s_cmp_eq_u32 s40, s41
    s_cbranch_scc1 G_xb
G1_s2:
    s_waitcnt lgkmcnt(12)
    v_mfma_f32_16x16x32_bf16 v[0:3], v[128:131], v[112:115], v[0:3]
    ds_read_b64_tr_b16 v[156:157], v200 offset:40960
    v_mfma_f32_16x16x32_bf16 v[28:31], v[128:131], v[116:119], v[28:31]
    ds_read_b64_tr_b16 v[158:159], v200 offset:41984
    v_mfma_f32_16x16x32_bf16 v[56:59], v[128:131], v[120:123], v[56:59]
    ds_read_b64_tr_b16 v[160:161], v201 offset:40960
    v_mfma_f32_16x16x32_bf16 v[84:87], v[128:131], v[124:127], v[84:87]
    ds_read_b64_tr_b16 v[162:163], v201 offset:41984
    s_waitcnt lgkmcnt(14)
    v_mfma_f32_16x16x32_bf16 v[4:7], v[132:135], v[112:115], v[4:7]
    ds_read_b64_tr_b16 v[164:165], v202 offset:40960
    v_mfma_f32_16x16x32_bf16 v[32:35], v[132:135], v[116:119], v[32:35]
    ds_read_b64_tr_b16 v[166:167], v202 offset:41984
    v_mfma_f32_16x16x32_bf16 v[60:63], v[132:135], v[120:123], v[60:63]
    ds_read_b64_tr_b16 v[168:169], v203 offset:40960
    v_mfma_f32_16x16x32_bf16 v[88:91], v[132:135], v[124:127], v[88:91]
    ds_read_b64_tr_b16 v[170:171], v203 offset:41984
    s_waitcnt lgkmcnt(15)
    v_mfma_f32_16x16x32_bf16 v[8:11], v[136:139], v[112:115], v[8:11]
    ds_read_b64_tr_b16 v[172:173], v235 offset:16384
    v_mfma_f32_16x16x32_bf16 v[36:39], v[136:139], v[116:119], v[36:39]
    ds_read_b64_tr_b16 v[174:175], v235 offset:18432
    v_mfma_f32_16x16x32_bf16 v[64:67], v[136:139], v[120:123], v[64:67]
    ds_read_b64_tr_b16 v[176:177], v236 offset:16384
    v_mfma_f32_16x16x32_bf16 v[92:95], v[136:139], v[124:127], v[92:95]
    ds_read_b64_tr_b16 v[178:179], v236 offset:18432
    s_waitcnt lgkmcnt(15)
    v_mfma_f32_16x16x32_bf16 v[12:15], v[140:143], v[112:115], v[12:15]
    ds_read_b64_tr_b16 v[180:181], v237 offset:16384
    v_mfma_f32_16x16x32_bf16 v[40:43], v[140:143], v[116:119], v[40:43]
    ds_read_b64_tr_b16 v[182:183], v237 offset:18432
    v_mfma_f32_16x16x32_bf16 v[68:71], v[140:143], v[120:123], v[68:71]
    ds_read_b64_tr_b16 v[184:185], v238 offset:16384
    v_mfma_f32_16x16x32_bf16 v[96:99], v[140:143], v[124:127], v[96:99]
    ds_read_b64_tr_b16 v[186:187], v238 offset:18432
    s_waitcnt lgkmcnt(15)
    v_mfma_f32_16x16x32_bf16 v[16:19], v[144:147], v[112:115], v[16:19]
    ds_read_b64_tr_b16 v[188:189], v239 offset:16384
    v_mfma_f32_16x16x32_bf16 v[44:47], v[144:147], v[116:119], v[44:47]
    ds_read_b64_tr_b16 v[190:191], v239 offset:18432
    v_mfma_f32_16x16x32_bf16 v[72:75], v[144:147], v[120:123], v[72:75]
    ds_read_b64_tr_b16 v[192:193], v211 offset:16384
    v_mfma_f32_16x16x32_bf16 v[100:103], v[144:147], v[124:127], v[100:103]
    ds_read_b64_tr_b16 v[194:195], v211 offset:18432
    s_waitcnt lgkmcnt(15)
    v_mfma_f32_16x16x32_bf16 v[20:23], v[148:151], v[112:115], v[20:23]
    ds_read_b64_tr_b16 v[196:197], v232 offset:16384
    v_mfma_f32_16x16x32_bf16 v[48:51], v[148:151], v[116:119], v[48:51]
    ds_read_b64_tr_b16 v[198:199], v232 offset:18432
    v_mfma_f32_16x16x32_bf16 v[76:79], v[148:151], v[120:123], v[76:79]
    v_mfma_f32_16x16x32_bf16 v[104:107], v[148:151], v[124:127], v[104:107]
    s_waitcnt lgkmcnt(15)
    v_mfma_f32_16x16x32_bf16 v[24:27], v[152:155], v[112:115], v[24:27]
    v_mfma_f32_16x16x32_bf16 v[52:55], v[152:155], v[116:119], v[52:55]
    s_add_u32 s40, s40, 1
    v_mfma_f32_16x16x32_bf16 v[80:83], v[152:155], v[120:123], v[80:83]
    s_cmp_eq_u32 s40, 16
    v_mfma_f32_16x16x32_bf16 v[108:111], v[152:155], v[124:127], v[108:111]
    s_waitcnt lgkmcnt(0)
    s_barrier
    s_cbranch_scc1 G1_tail
    s_cmp_eq_u32 s40, s41
    s_cbranch_scc1 G_xa2
G_xar2:
    v_mfma_f32_16x16x32_bf16 v[0:3], v[172:175], v[156:159], v[0:3]
    ds_read_b64_tr_b16 v[112:113], v200 offset:0
    v_mfma_f32_16x16x32_bf16 v[28:31], v[172:175], v[160:163], v[28:31]
    ds_read_b64_tr_b16 v[114:115], v200 offset:1024
    v_mfma_f32_16x16x32_bf16 v[56:59], v[172:175], v[164:167], v[56:59]
    ds_read_b64_tr_b16 v[116:117], v201 offset:0
    v_mfma_f32_16x16x32_bf16 v[84:87], v[172:175], v[168:171], v[84:87]
    ds_read_b64_tr_b16 v[118:119], v201 offset:1024
    v_mfma_f32_16x16x32_bf16 v[4:7], v[176:179], v[156:159], v[4:7]
    ds_read_b64_tr_b16 v[120:121], v202 offset:0
    v_mfma_f32_16x16x32_bf16 v[32:35], v[176:179], v[160:163], v[32:35]
    ds_read_b64_tr_b16 v[122:123], v202 offset:1024
    v_mfma_f32_16x16x32_bf16 v[60:63], v[176:179], v[164:167], v[60:63]
    ds_read_b64_tr_b16 v[124:125], v203 offset:0
    v_mfma_f32_16x16x32_bf16 v[88:91], v[176:179], v[168:171], v[88:91]
    ds_read_b64_tr_b16 v[126:127], v203 offset:1024
    v_mfma_f32_16x16x32_bf16 v[8:11], v[180:183], v[156:159], v[8:11]
    ds_read_b64_tr_b16 v[128:129], v204 offset:0
    v_mfma_f32_16x16x32_bf16 v[36:39], v[180:183], v[160:163], v[36:39]
    ds_read_b64_tr_b16 v[130:131], v204 offset:2048
    v_mfma_f32_16x16x32_bf16 v[64:67], v[180:183], v[164:167], v[64:67]
    ds_read_b64_tr_b16 v[132:133], v205 offset:0
    v_mfma_f32_16x16x32_bf16 v[92:95], v[180:183], v[168:171], v[92:95]
    ds_read_b64_tr_b16 v[134:135], v205 offset:2048
    v_mfma_f32_16x16x32_bf16 v[12:15], v[184:187], v[156:159], v[12:15]
    ds_read_b64_tr_b16 v[136:137], v206 offset:0
    v_mfma_f32_16x16x32_bf16 v[40:43], v[184:187], v[160:163], v[40:43]
    ds_read_b64_tr_b16 v[138:139], v206 offset:2048
    v_mfma_f32_16x16x32_bf16 v[68:71], v[184:187], v[164:167], v[68:71]
    ds_read_b64_tr_b16 v[140:141], v207 offset:0
    v_mfma_f32_16x16x32_bf16 v[96:99], v[184:187], v[168:171], v[96:99]
    ds_read_b64_tr_b16 v[142:143], v207 offset:2048
    v_mfma_f32_16x16x32_bf16 v[16:19], v[188:191], v[156:159], v[16:19]
    ds_read_b64_tr_b16 v[144:145], v208 offset:0
    v_mfma_f32_16x16x32_bf16 v[44:47], v[188:191], v[160:163], v[44:47]
    ds_read_b64_tr_b16 v[146:147], v208 offset:2048
    v_mfma_f32_16x16x32_bf16 v[72:75], v[188:191], v[164:167], v[72:75]
    ds_read_b64_tr_b16 v[148:149], v209 offset:0
    v_mfma_f32_16x16x32_bf16 v[100:103], v[188:191], v[168:171], v[100:103]
    ds_read_b64_tr_b16 v[150:151], v209 offset:2048
    v_mfma_f32_16x16x32_bf16 v[20:23], v[192:195], v[156:159], v[20:23]
    ds_read_b64_tr_b16 v[152:153], v210 offset:0
    v_mfma_f32_16x16x32_bf16 v[48:51], v[192:195], v[160:163], v[48:51]
    ds_read_b64_tr_b16 v[154:155], v210 offset:2048
    v_mfma_f32_16x16x32_bf16 v[76:79], v[192:195], v[164:167], v[76:79]
    v_mfma_f32_16x16x32_bf16 v[104:107], v[192:195], v[168:171], v[104:107]
    v_mfma_f32_16x16x32_bf16 v[24:27], v[196:199], v[156:159], v[24:27]
    v_mfma_f32_16x16x32_bf16 v[52:55], v[196:199], v[160:163], v[52:55]
    v_mfma_f32_16x16x32_bf16 v[80:83], v[196:199], v[164:167], v[80:83]
    v_mfma_f32_16x16x32_bf16 v[108:111], v[196:199], v[168:171], v[108:111]
    s_cmp_eq_u32 s40, s41
    s_cbranch_scc1 G_xb
    s_branch G1_s0
G1_tail:
    v_mfma_f32_16x16x32_bf16 v[0:3], v[172:175], v[156:159], v[0:3]
    ds_read_b64 v[128:129], v252
    v_mfma_f32_16x16x32_bf16 v[28:31], v[172:175], v[160:163], v[28:31]
    ds_read_b64 v[130:131], v253
    v_mfma_f32_16x16x32_bf16 v[4:7], v[176:179], v[156:159], v[4:7]
    ds_read_b64 v[132:133], v254
    v_mfma_f32_16x16x32_bf16 v[32:35], v[176:179], v[160:163], v[32:35]
    ds_read_b64 v[134:135], v255
    v_mfma_f32_16x16x32_bf16 v[8:11], v[180:183], v[156:159], v[8:11]
    ds_read_b64 v[112:113], v233 offset:0
    v_mfma_f32_16x16x32_bf16 v[36:39], v[180:183], v[160:163], v[36:39]
    ds_read_b64 v[114:115], v233 offset:128
    v_mfma_f32_16x16x32_bf16 v[12:15], v[184:187], v[156:159], v[12:15]
    ds_read_b64 v[116:117], v233 offset:256
    v_mfma_f32_16x16x32_bf16 v[40:43], v[184:187], v[160:163], v[40:43]
    ds_read_b64 v[118:119], v233 offset:384
    v_mfma_f32_16x16x32_bf16 v[16:19], v[188:191], v[156:159], v[16:19]
    ds_read_b64 v[120:121], v233 offset:512
    v_mfma_f32_16x16x32_bf16 v[44:47], v[188:191], v[160:163], v[44:47]
    ds_read_b64 v[122:123], v233 offset:640
    v_mfma_f32_16x16x32_bf16 v[20:23], v[192:195], v[156:159], v[20:23]
    ds_read_b64 v[124:125], v233 offset:768
    v_mfma_f32_16x16x32_bf16 v[48:51], v[192:195], v[160:163], v[48:51]
    v_xad_u32 v213, v246, s76, v247
    v_xad_u32 v214, v246, s77, v247
    v_mfma_f32_16x16x32_bf16 v[24:27], v[196:199], v[156:159], v[24:27]
    v_xad_u32 v215, v246, s78, v247
    v_xad_u32 v217, v246, s79, v247
    v_mfma_f32_16x16x32_bf16 v[52:55], v[196:199], v[160:163], v[52:55]
    v_xad_u32 v218, v246, s60, v247
    v_xad_u32 v219, v246, s61, v247
    v_mfma_f32_16x16x32_bf16 v[56:59], v[172:175], v[164:167], v[56:59]
    v_xad_u32 v221, v246, s62, v247
    v_mfma_f32_16x16x32_bf16 v[84:87], v[172:175], v[168:171], v[84:87]
    s_waitcnt lgkmcnt(0)
    v_mfma_f32_16x16x16_bf16 v[0:3], v[112:113], v[128:129], v[0:3]
    v_mfma_f32_16x16x16_bf16 v[28:31], v[112:113], v[130:131], v[28:31]
    v_mfma_f32_16x16x16_bf16 v[4:7], v[114:115], v[128:129], v[4:7]
    v_mfma_f32_16x16x16_bf16 v[32:35], v[114:115], v[130:131], v[32:35]
    v_mfma_f32_16x16x16_bf16 v[8:11], v[116:117], v[128:129], v[8:11]
    v_mfma_f32_16x16x16_bf16 v[36:39], v[116:117], v[130:131], v[36:39]
    v_mfma_f32_16x16x16_bf16 v[12:15], v[118:119], v[128:129], v[12:15]
    v_mfma_f32_16x16x16_bf16 v[40:43], v[118:119], v[130:131], v[40:43]
    v_mfma_f32_16x16x16_bf16 v[16:19], v[120:121], v[128:129], v[16:19]
    v_mfma_f32_16x16x16_bf16 v[44:47], v[120:121], v[130:131], v[44:47]
    v_max_f32 v0, 0, v0
    v_max_f32 v1, 0, v1
    v_max_f32 v2, 0, v2
    v_max_f32 v3, 0, v3
    v_pk_mul_f32 v[0:1], v[0:1], v[0:1]
    v_pk_mul_f32 v[2:3], v[2:3], v[2:3]
    v_cvt_pk_bf16_f32 v0, v0, v1
    v_cvt_pk_bf16_f32 v1, v2, v3
    ds_write_b64 v213, v[0:1] offset:0
    v_mfma_f32_16x16x16_bf16 v[20:23], v[122:123], v[128:129], v[20:23]
    v_mfma_f32_16x16x16_bf16 v[48:51], v[122:123], v[130:131], v[48:51]
    v_max_f32 v28, 0, v28
    v_max_f32 v29, 0, v29
    v_max_f32 v30, 0, v30
    v_max_f32 v31, 0, v31
    v_pk_mul_f32 v[28:29], v[28:29], v[28:29]
    v_pk_mul_f32 v[30:31], v[30:31], v[30:31]
    v_cvt_pk_bf16_f32 v28, v28, v29
    v_cvt_pk_bf16_f32 v29, v30, v31
    ds_write_b64 v213, v[28:29] offset:2048
    v_mfma_f32_16x16x16_bf16 v[24:27], v[124:125], v[128:129], v[24:27]
    v_mfma_f32_16x16x16_bf16 v[52:55], v[124:125], v[130:131], v[52:55]
    v_max_f32 v4, 0, v4
    v_max_f32 v5, 0, v5
    v_max_f32 v6, 0, v6
    v_max_f32 v7, 0, v7
    v_pk_mul_f32 v[4:5], v[4:5], v[4:5]
    v_pk_mul_f32 v[6:7], v[6:7], v[6:7]
    v_cvt_pk_bf16_f32 v4, v4, v5
    v_cvt_pk_bf16_f32 v5, v6, v7
    ds_write_b64 v214, v[4:5] offset:0
    v_mfma_f32_16x16x32_bf16 v[60:63], v[176:179], v[164:167], v[60:63]
    v_mfma_f32_16x16x32_bf16 v[88:91], v[176:179], v[168:171], v[88:91]
    v_max_f32 v32, 0, v32
    v_max_f32 v33, 0, v33
    v_max_f32 v34, 0, v34
    v_max_f32 v35, 0, v35
    v_pk_mul_f32 v[32:33], v[32:33], v[32:33]
    v_pk_mul_f32 v[34:35], v[34:35], v[34:35]
    v_cvt_pk_bf16_f32 v32, v32, v33
    v_cvt_pk_bf16_f32 v33, v34, v35
    ds_write_b64 v214, v[32:33] offset:2048
    v_mfma_f32_16x16x32_bf16 v[64:67], v[180:183], v[164:167], v[64:67]
    v_mfma_f32_16x16x32_bf16 v[92:95], v[180:183], v[168:171], v[92:95]
    v_max_f32 v8, 0, v8
    v_max_f32 v9, 0, v9
    v_max_f32 v10, 0, v10
    v_max_f32 v11, 0, v11
    v_pk_mul_f32 v[8:9], v[8:9], v[8:9]
    v_pk_mul_f32 v[10:11], v[10:11], v[10:11]
    v_cvt_pk_bf16_f32 v8, v8, v9
    v_cvt_pk_bf16_f32 v9, v10, v11
    ds_write_b64 v215, v[8:9] offset:0
    v_mfma_f32_16x16x32_bf16 v[68:71], v[184:187], v[164:167], v[68:71]
    v_mfma_f32_16x16x32_bf16 v[96:99], v[184:187], v[168:171], v[96:99]
    v_max_f32 v36, 0, v36
    v_max_f32 v37, 0, v37
    v_max_f32 v38, 0, v38
    v_max_f32 v39, 0, v39
    v_pk_mul_f32 v[36:37], v[36:37], v[36:37]
    v_pk_mul_f32 v[38:39], v[38:39], v[38:39]
    v_cvt_pk_bf16_f32 v36, v36, v37
    v_cvt_pk_bf16_f32 v37, v38, v39
    ds_write_b64 v215, v[36:37] offset:2048
    v_mfma_f32_16x16x32_bf16 v[72:75], v[188:191], v[164:167], v[72:75]
    v_mfma_f32_16x16x32_bf16 v[100:103], v[188:191], v[168:171], v[100:103]
    v_max_f32 v12, 0, v12
    v_max_f32 v13, 0, v13
    v_max_f32 v14, 0, v14
    v_max_f32 v15, 0, v15
    v_pk_mul_f32 v[12:13], v[12:13], v[12:13]
    v_pk_mul_f32 v[14:15], v[14:15], v[14:15]
    v_cvt_pk_bf16_f32 v12, v12, v13
    v_cvt_pk_bf16_f32 v13, v14, v15
    ds_write_b64 v217, v[12:13] offset:0
    v_mfma_f32_16x16x32_bf16 v[76:79], v[192:195], v[164:167], v[76:79]
    v_mfma_f32_16x16x32_bf16 v[104:107], v[192:195], v[168:171], v[104:107]
    v_max_f32 v40, 0, v40
    v_max_f32 v41, 0, v41
    v_max_f32 v42, 0, v42
    v_max_f32 v43, 0, v43
    v_pk_mul_f32 v[40:41], v[40:41], v[40:41]
    v_pk_mul_f32 v[42:43], v[42:43], v[42:43]
    v_cvt_pk_bf16_f32 v40, v40, v41
    v_cvt_pk_bf16_f32 v41, v42, v43
    ds_write_b64 v217, v[40:41] offset:2048
    v_mfma_f32_16x16x32_bf16 v[80:83], v[196:199], v[164:167], v[80:83]
    v_mfma_f32_16x16x32_bf16 v[108:111], v[196:199], v[168:171], v[108:111]
    v_max_f32 v16, 0, v16
    v_max_f32 v17, 0, v17
    v_max_f32 v18, 0, v18
    v_max_f32 v19, 0, v19
    v_pk_mul_f32 v[16:17], v[16:17], v[16:17]
    v_pk_mul_f32 v[18:19], v[18:19], v[18:19]
    v_cvt_pk_bf16_f32 v16, v16, v17
    v_cvt_pk_bf16_f32 v17, v18, v19
    ds_write_b64 v218, v[16:17] offset:0
    v_mfma_f32_16x16x16_bf16 v[56:59], v[112:113], v[132:133], v[56:59]
    v_mfma_f32_16x16x16_bf16 v[84:87], v[112:113], v[134:135], v[84:87]
    v_max_f32 v44, 0, v44
    v_max_f32 v45, 0, v45
    v_max_f32 v46, 0, v46
    v_max_f32 v47, 0, v47
    v_pk_mul_f32 v[44:45], v[44:45], v[44:45]
    v_pk_mul_f32 v[46:47], v[46:47], v[46:47]
    v_cvt_pk_bf16_f32 v44, v44, v45
    v_cvt_pk_bf16_f32 v45, v46, v47
    ds_write_b64 v218, v[44:45] offset:2048
    v_mfma_f32_16x16x16_bf16 v[60:63], v[114:115], v[132:133], v[60:63]
    v_mfma_f32_16x16x16_bf16 v[88:91], v[114:115], v[134:135], v[88:91]
    v_mfma_f32_16x16x16_bf16 v[64:67], v[116:117], v[132:133], v[64:67]
    v_max_f32 v20, 0, v20
    v_max_f32 v21, 0, v21
    v_max_f32 v22, 0, v22
    v_max_f32 v23, 0, v23
    v_pk_mul_f32 v[20:21], v[20:21], v[20:21]
    v_pk_mul_f32 v[22:23], v[22:23], v[22:23]
    v_cvt_pk_bf16_f32 v20, v20, v21
    v_cvt_pk_bf16_f32 v21, v22, v23
    ds_write_b64 v219, v[20:21] offset:0
    v_mfma_f32_16x16x16_bf16 v[92:95], v[116:117], v[134:135], v[92:95]
    v_mfma_f32_16x16x16_bf16 v[68:71], v[118:119], v[132:133], v[68:71]
    v_mfma_f32_16x16x16_bf16 v[96:99], v[118:119], v[134:135], v[96:99]
    v_max_f32 v48, 0, v48
    v_max_f32 v49, 0, v49
    v_max_f32 v50, 0, v50
    v_max_f32 v51, 0, v51
    v_pk_mul_f32 v[48:49], v[48:49], v[48:49]
    v_pk_mul_f32 v[50:51], v[50:51], v[50:51]
    v_cvt_pk_bf16_f32 v48, v48, v49
    v_cvt_pk_bf16_f32 v49, v50, v51
    ds_write_b64 v219, v[48:49] offset:2048
    v_mfma_f32_16x16x16_bf16 v[72:75], v[120:121], v[132:133], v[72:75]
    v_mfma_f32_16x16x16_bf16 v[100:103], v[120:121], v[134:135], v[100:103]
    v_mfma_f32_16x16x16_bf16 v[76:79], v[122:123], v[132:133], v[76:79]
    v_max_f32 v24, 0, v24
    v_max_f32 v25, 0, v25
    v_max_f32 v26, 0, v26
    v_max_f32 v27, 0, v27
    v_pk_mul_f32 v[24:25], v[24:25], v[24:25]
    v_pk_mul_f32 v[26:27], v[26:27], v[26:27]
    v_cvt_pk_bf16_f32 v24, v24, v25
    v_cvt_pk_bf16_f32 v25, v26, v27
    ds_write_b64 v221, v[24:25] offset:0
    v_mfma_f32_16x16x16_bf16 v[104:107], v[122:123], v[134:135], v[104:107]
    v_mfma_f32_16x16x16_bf16 v[80:83], v[124:125], v[132:133], v[80:83]
    v_mfma_f32_16x16x16_bf16 v[108:111], v[124:125], v[134:135], v[108:111]
    v_max_f32 v52, 0, v52
    v_max_f32 v53, 0, v53
    v_max_f32 v54, 0, v54
    v_max_f32 v55, 0, v55
    v_pk_mul_f32 v[52:53], v[52:53], v[52:53]
    v_pk_mul_f32 v[54:55], v[54:55], v[54:55]
    v_cvt_pk_bf16_f32 v52, v52, v53
    v_cvt_pk_bf16_f32 v53, v54, v55
    ds_write_b64 v221, v[52:53] offset:2048
    s_waitcnt lgkmcnt(0)
    s_barrier
    v_max_f32 v56, 0, v56
    v_max_f32 v57, 0, v57
    v_max_f32 v58, 0, v58
    v_max_f32 v59, 0, v59
    v_pk_mul_f32 v[56:57], v[56:57], v[56:57]
    v_pk_mul_f32 v[58:59], v[58:59], v[58:59]
    v_cvt_pk_bf16_f32 v56, v56, v57
    v_cvt_pk_bf16_f32 v57, v58, v59
    ds_write_b64 v213, v[56:57] offset:4096
    v_max_f32 v84, 0, v84
    v_max_f32 v85, 0, v85
    v_max_f32 v86, 0, v86
    v_max_f32 v87, 0, v87
    v_pk_mul_f32 v[84:85], v[84:85], v[84:85]
    v_pk_mul_f32 v[86:87], v[86:87], v[86:87]
    v_cvt_pk_bf16_f32 v84, v84, v85
    v_cvt_pk_bf16_f32 v85, v86, v87
    ds_write_b64 v213, v[84:85] offset:6144
    v_max_f32 v60, 0, v60
    v_max_f32 v61, 0, v61
    v_max_f32 v62, 0, v62
    v_max_f32 v63, 0, v63
    v_pk_mul_f32 v[60:61], v[60:61], v[60:61]
    v_pk_mul_f32 v[62:63], v[62:63], v[62:63]
    v_cvt_pk_bf16_f32 v60, v60, v61
    v_cvt_pk_bf16_f32 v61, v62, v63
    ds_write_b64 v214, v[60:61] offset:4096
    v_max_f32 v88, 0, v88
    v_max_f32 v89, 0, v89
    v_max_f32 v90, 0, v90
    v_max_f32 v91, 0, v91
    v_pk_mul_f32 v[88:89], v[88:89], v[88:89]
    v_pk_mul_f32 v[90:91], v[90:91], v[90:91]
    v_cvt_pk_bf16_f32 v88, v88, v89
    v_cvt_pk_bf16_f32 v89, v90, v91
    ds_write_b64 v214, v[88:89] offset:6144
    v_max_f32 v64, 0, v64
    v_max_f32 v65, 0, v65
    v_max_f32 v66, 0, v66
    v_max_f32 v67, 0, v67
    v_pk_mul_f32 v[64:65], v[64:65], v[64:65]
    v_pk_mul_f32 v[66:67], v[66:67], v[66:67]
    v_cvt_pk_bf16_f32 v64, v64, v65
    v_cvt_pk_bf16_f32 v65, v66, v67
    ds_write_b64 v215, v[64:65] offset:4096
    v_max_f32 v92, 0, v92
    v_max_f32 v93, 0, v93
    v_max_f32 v94, 0, v94
    v_max_f32 v95, 0, v95
    v_pk_mul_f32 v[92:93], v[92:93], v[92:93]
    v_pk_mul_f32 v[94:95], v[94:95], v[94:95]
    v_cvt_pk_bf16_f32 v92, v92, v93
    v_cvt_pk_bf16_f32 v93, v94, v95
    ds_write_b64 v215, v[92:93] offset:6144
    v_max_f32 v68, 0, v68
    v_max_f32 v69, 0, v69
    v_max_f32 v70, 0, v70
    v_max_f32 v71, 0, v71
    v_pk_mul_f32 v[68:69], v[68:69], v[68:69]
    v_pk_mul_f32 v[70:71], v[70:71], v[70:71]
    v_cvt_pk_bf16_f32 v68, v68, v69
    v_cvt_pk_bf16_f32 v69, v70, v71
    ds_write_b64 v217, v[68:69] offset:4096
    v_max_f32 v96, 0, v96
    v_max_f32 v97, 0, v97
    v_max_f32 v98, 0, v98
    v_max_f32 v99, 0, v99
    v_pk_mul_f32 v[96:97], v[96:97], v[96:97]
    v_pk_mul_f32 v[98:99], v[98:99], v[98:99]
    v_cvt_pk_bf16_f32 v96, v96, v97
    v_cvt_pk_bf16_f32 v97, v98, v99
    ds_write_b64 v217, v[96:97] offset:6144
    v_max_f32 v72, 0, v72
    v_max_f32 v73, 0, v73
    v_max_f32 v74, 0, v74
    v_max_f32 v75, 0, v75
    v_pk_mul_f32 v[72:73], v[72:73], v[72:73]
    v_pk_mul_f32 v[74:75], v[74:75], v[74:75]
    v_cvt_pk_bf16_f32 v72, v72, v73
    v_cvt_pk_bf16_f32 v73, v74, v75
    ds_write_b64 v218, v[72:73] offset:4096
    v_max_f32 v100, 0, v100
    v_max_f32 v101, 0, v101
    v_max_f32 v102, 0, v102
    v_max_f32 v103, 0, v103
    v_pk_mul_f32 v[100:101], v[100:101], v[100:101]
    v_pk_mul_f32 v[102:103], v[102:103], v[102:103]
    v_cvt_pk_bf16_f32 v100, v100, v101
    v_cvt_pk_bf16_f32 v101, v102, v103
    ds_write_b64 v218, v[100:101] offset:6144
    v_max_f32 v76, 0, v76
    v_max_f32 v77, 0, v77
    v_max_f32 v78, 0, v78
    v_max_f32 v79, 0, v79
    v_pk_mul_f32 v[76:77], v[76:77], v[76:77]
    v_pk_mul_f32 v[78:79], v[78:79], v[78:79]
    v_cvt_pk_bf16_f32 v76, v76, v77
    v_cvt_pk_bf16_f32 v77, v78, v79
    ds_write_b64 v219, v[76:77] offset:4096
    v_max_f32 v104, 0, v104
    v_max_f32 v105, 0, v105
    v_max_f32 v106, 0, v106
    v_max_f32 v107, 0, v107
    v_pk_mul_f32 v[104:105], v[104:105], v[104:105]
    v_pk_mul_f32 v[106:107], v[106:107], v[106:107]
    v_cvt_pk_bf16_f32 v104, v104, v105
    v_cvt_pk_bf16_f32 v105, v106, v107
    ds_write_b64 v219, v[104:105] offset:6144
    v_max_f32 v80, 0, v80
    v_max_f32 v81, 0, v81
    v_max_f32 v82, 0, v82
    v_max_f32 v83, 0, v83
    v_pk_mul_f32 v[80:81], v[80:81], v[80:81]
    v_pk_mul_f32 v[82:83], v[82:83], v[82:83]
    v_cvt_pk_bf16_f32 v80, v80, v81
    v_cvt_pk_bf16_f32 v81, v82, v83
    ds_write_b64 v221, v[80:81] offset:4096
    v_max_f32 v108, 0, v108
    v_max_f32 v109, 0, v109
    v_max_f32 v110, 0, v110
    v_max_f32 v111, 0, v111
    v_pk_mul_f32 v[108:109], v[108:109], v[108:109]
    v_pk_mul_f32 v[110:111], v[110:111], v[110:111]
    v_cvt_pk_bf16_f32 v108, v108, v109
    v_cvt_pk_bf16_f32 v109, v110, v111
    ds_write_b64 v221, v[108:109] offset:6144
    s_waitcnt lgkmcnt(0)
    s_barrier
    s_lshl_b32 s36, s55, 8
    s_lshl_b32 s38, s35, 7
    s_add_u32 s36, s36, s38
    s_mov_b32 s16, s50
    s_mov_b32 s17, s51
    s_mov_b32 s18, 0x800
    s_mov_b32 s19, 0x00020000
    buffer_load_dwordx2 v[232:233], v243, s[16:19], s36 offen offset:0
    buffer_load_dwordx2 v[234:235], v243, s[16:19], s36 offen offset:32
    buffer_load_dwordx2 v[236:237], v243, s[16:19], s36 offen offset:64
    buffer_load_dwordx2 v[238:239], v243, s[16:19], s36 offen offset:96
    s_lshl_b32 s36, s34, 13
    s_lshl_b32 s37, s54, 12
    s_add_u32 s36, s36, s37
    v_lshl_add_u32 v204, v241, 7, s36
    v_xor_b32 v206, v242, v245
    v_lshl_add_u32 v128, v206, 4, v204
    v_xor_b32 v129, 64, v128
    v_xor_b32 v130, 4096, v128
    v_xor_b32 v131, 4096, v129
    v_bfe_u32 v206, v240, 2, 2
    v_lshl_add_u32 v207, v242, 3, v206
    v_lshlrev_b32 v207, 8, v207
    v_and_b32 v208, 3, v240
    v_lshl_add_u32 v207, v208, 3, v207
    v_add_u32 v207, 81920, v207
    v_and_b32 v208, 1, v242
    v_lshl_or_b32 v206, v208, 2, v206
    s_lshl_b32 s37, s35, 2
    s_add_u32 s38, s37, 0
    v_xor_b32 v208, s38, v206
    v_lshl_add_u32 v132, v208, 5, v207
    s_add_u32 s38, s37, 1
    v_xor_b32 v208, s38, v206
    v_lshl_add_u32 v133, v208, 5, v207
    s_add_u32 s38, s37, 2
    v_xor_b32 v208, s38, v206
    v_lshl_add_u32 v134, v208, 5, v207
    s_add_u32 s38, s37, 3
    v_xor_b32 v208, s38, v206
    v_lshl_add_u32 v135, v208, 5, v207
    v_mov_b64 v[0:1], 0
    v_mov_b64 v[2:3], 0
    v_mov_b64 v[4:5], 0
    v_mov_b64 v[6:7], 0
    v_mov_b64 v[8:9], 0
    v_mov_b64 v[10:11], 0
    v_mov_b64 v[12:13], 0
    v_mov_b64 v[14:15], 0
    v_mov_b64 v[16:17], 0
    v_mov_b64 v[18:19], 0
    v_mov_b64 v[20:21], 0
    v_mov_b64 v[22:23], 0
    v_mov_b64 v[24:25], 0
    v_mov_b64 v[26:27], 0
    v_mov_b64 v[28:29], 0
    v_mov_b64 v[30:31], 0
    v_mov_b64 v[32:33], 0
    v_mov_b64 v[34:35], 0
    v_mov_b64 v[36:37], 0
    v_mov_b64 v[38:39], 0
    v_mov_b64 v[40:41], 0
    v_mov_b64 v[42:43], 0
    v_mov_b64 v[44:45], 0
    v_mov_b64 v[46:47], 0
    v_mov_b64 v[48:49], 0
    v_mov_b64 v[50:51], 0
    v_mov_b64 v[52:53], 0
    v_mov_b64 v[54:55], 0
    v_mov_b64 v[56:57], 0
    v_mov_b64 v[58:59], 0
    v_mov_b64 v[60:61], 0
    v_mov_b64 v[62:63], 0
    s_mov_b32 s40, 0
    s_cmp_eq_u32 s29, 0
    s_cbranch_scc1 G2_e0
    ds_read_b128 v[64:67], v128 offset:16384
    ds_read_b128 v[68:71], v128 offset:18432
    ds_read_b128 v[72:75], v130 offset:16384
    ds_read_b128 v[76:79], v130 offset:18432
    ds_read_b64_tr_b16 v[80:81], v132 offset:16384
    ds_read_b64_tr_b16 v[82:83], v132 offset:17408
    ds_read_b64_tr_b16 v[84:85], v133 offset:16384
    ds_read_b64_tr_b16 v[86:87], v133 offset:17408
    ds_read_b64_tr_b16 v[88:89], v134 offset:16384
    ds_read_b64_tr_b16 v[90:91], v134 offset:17408
    ds_read_b64_tr_b16 v[92:93], v135 offset:16384
    ds_read_b64_tr_b16 v[94:95], v135 offset:17408
    s_branch G2_s1
G2_e0:
    ds_read_b128 v[64:67], v128 offset:0
    ds_read_b128 v[68:71], v128 offset:2048
    ds_read_b128 v[72:75], v130 offset:0
    ds_read_b128 v[76:79], v130 offset:2048
    ds_read_b64_tr_b16 v[80:81], v132 offset:0
    ds_read_b64_tr_b16 v[82:83], v132 offset:1024
    ds_read_b64_tr_b16 v[84:85], v133 offset:0
    ds_read_b64_tr_b16 v[86:87], v133 offset:1024
    ds_read_b64_tr_b16 v[88:89], v134 offset:0
    ds_read_b64_tr_b16 v[90:91], v134 offset:1024
    ds_read_b64_tr_b16 v[92:93], v135 offset:0
    ds_read_b64_tr_b16 v[94:95], v135 offset:1024
G2_s0:
    s_waitcnt lgkmcnt(6)
    v_mfma_f32_16x16x32_bf16 v[0:3], v[80:83], v[64:67], v[0:3]
    ds_read_b128 v[96:99], v129 offset:0
    v_mfma_f32_16x16x32_bf16 v[16:19], v[80:83], v[68:71], v[16:19]
    ds_read_b128 v[100:103], v129 offset:2048
    v_mfma_f32_16x16x32_bf16 v[32:35], v[80:83], v[72:75], v[32:35]
    ds_read_b128 v[104:107], v131 offset:0
    v_mfma_f32_16x16x32_bf16 v[48:51], v[80:83], v[76:79], v[48:51]
    ds_read_b128 v[108:111], v131 offset:2048
    s_waitcnt lgkmcnt(8)
    v_mfma_f32_16x16x32_bf16 v[4:7], v[84:87], v[64:67], v[4:7]
    ds_read_b64_tr_b16 v[112:113], v132 offset:8192
    v_mfma_f32_16x16x32_bf16 v[20:23], v[84:87], v[68:71], v[20:23]
    ds_read_b64_tr_b16 v[114:115], v132 offset:9216
    v_mfma_f32_16x16x32_bf16 v[36:39], v[84:87], v[72:75], v[36:39]
    ds_read_b64_tr_b16 v[116:117], v133 offset:8192
    v_mfma_f32_16x16x32_bf16 v[52:55], v[84:87], v[76:79], v[52:55]
    ds_read_b64_tr_b16 v[118:119], v133 offset:9216
    s_waitcnt lgkmcnt(10)
    v_mfma_f32_16x16x32_bf16 v[8:11], v[88:91], v[64:67], v[8:11]
    ds_read_b64_tr_b16 v[120:121], v134 offset:8192
    v_mfma_f32_16x16x32_bf16 v[24:27], v[88:91], v[68:71], v[24:27]
    ds_read_b64_tr_b16 v[122:123], v134 offset:9216
    v_mfma_f32_16x16x32_bf16 v[40:43], v[88:91], v[72:75], v[40:43]
    ds_read_b64_tr_b16 v[124:125], v135 offset:8192
    v_mfma_f32_16x16x32_bf16 v[56:59], v[88:91], v[76:79], v[56:59]
    ds_read_b64_tr_b16 v[126:127], v135 offset:9216
    s_waitcnt lgkmcnt(12)
    v_mfma_f32_16x16x32_bf16 v[12:15], v[92:95], v[64:67], v[12:15]
    v_mfma_f32_16x16x32_bf16 v[28:31], v[92:95], v[68:71], v[28:31]
    s_add_u32 s40, s40, 1
    v_mfma_f32_16x16x32_bf16 v[44:47], v[92:95], v[72:75], v[44:47]
    s_cmp_eq_u32 s40, 28
    v_mfma_f32_16x16x32_bf16 v[60:63], v[92:95], v[76:79], v[60:63]
    s_cbranch_scc1 G2_tail
    s_waitcnt lgkmcnt(6)
    v_mfma_f32_16x16x32_bf16 v[0:3], v[112:115], v[96:99], v[0:3]
    v_mfma_f32_16x16x32_bf16 v[16:19], v[112:115], v[100:103], v[16:19]
    s_waitcnt lgkmcnt(0)
    s_barrier
    v_mfma_f32_16x16x32_bf16 v[32:35], v[112:115], v[104:107], v[32:35]
    ds_read_b128 v[64:67], v128 offset:16384
    v_mfma_f32_16x16x32_bf16 v[48:51], v[112:115], v[108:111], v[48:51]
    ds_read_b128 v[68:71], v128 offset:18432
    v_mfma_f32_16x16x32_bf16 v[4:7], v[116:119], v[96:99], v[4:7]
    ds_read_b128 v[72:75], v130 offset:16384
    v_mfma_f32_16x16x32_bf16 v[20:23], v[116:119], v[100:103], v[20:23]
    ds_read_b128 v[76:79], v130 offset:18432
    v_mfma_f32_16x16x32_bf16 v[36:39], v[116:119], v[104:107], v[36:39]
    ds_read_b64_tr_b16 v[80:81], v132 offset:16384
    v_mfma_f32_16x16x32_bf16 v[52:55], v[116:119], v[108:111], v[52:55]
    ds_read_b64_tr_b16 v[82:83], v132 offset:17408
    v_mfma_f32_16x16x32_bf16 v[8:11], v[120:123], v[96:99], v[8:11]
    ds_read_b64_tr_b16 v[84:85], v133 offset:16384
    v_mfma_f32_16x16x32_bf16 v[24:27], v[120:123], v[100:103], v[24:27]
    ds_read_b64_tr_b16 v[86:87], v133 offset:17408
    v_mfma_f32_16x16x32_bf16 v[40:43], v[120:123], v[104:107], v[40:43]
    ds_read_b64_tr_b16 v[88:89], v134 offset:16384
    v_mfma_f32_16x16x32_bf16 v[56:59], v[120:123], v[108:111], v[56:59]
    ds_read_b64_tr_b16 v[90:91], v134 offset:17408
    v_mfma_f32_16x16x32_bf16 v[12:15], v[124:127], v[96:99], v[12:15]
    ds_read_b64_tr_b16 v[92:93], v135 offset:16384
    v_mfma_f32_16x16x32_bf16 v[28:31], v[124:127], v[100:103], v[28:31]
    ds_read_b64_tr_b16 v[94:95], v135 offset:17408
    v_mfma_f32_16x16x32_bf16 v[44:47], v[124:127], v[104:107], v[44:47]
    v_mfma_f32_16x16x32_bf16 v[60:63], v[124:127], v[108:111], v[60:63]
G2_s1:
    s_waitcnt lgkmcnt(6)
    v_mfma_f32_16x16x32_bf16 v[0:3], v[80:83], v[64:67], v[0:3]
    ds_read_b128 v[96:99], v129 offset:16384
    v_mfma_f32_16x16x32_bf16 v[16:19], v[80:83], v[68:71], v[16:19]
    ds_read_b128 v[100:103], v129 offset:18432
    v_mfma_f32_16x16x32_bf16 v[32:35], v[80:83], v[72:75], v[32:35]
    ds_read_b128 v[104:107], v131 offset:16384
    v_mfma_f32_16x16x32_bf16 v[48:51], v[80:83], v[76:79], v[48:51]
    ds_read_b128 v[108:111], v131 offset:18432
    s_waitcnt lgkmcnt(8)
    v_mfma_f32_16x16x32_bf16 v[4:7], v[84:87], v[64:67], v[4:7]
    ds_read_b64_tr_b16 v[112:113], v132 offset:24576
    v_mfma_f32_16x16x32_bf16 v[20:23], v[84:87], v[68:71], v[20:23]
    ds_read_b64_tr_b16 v[114:115], v132 offset:25600
    v_mfma_f32_16x16x32_bf16 v[36:39], v[84:87], v[72:75], v[36:39]
    ds_read_b64_tr_b16 v[116:117], v133 offset:24576
    v_mfma_f32_16x16x32_bf16 v[52:55], v[84:87], v[76:79], v[52:55]
    ds_read_b64_tr_b16 v[118:119], v133 offset:25600
    s_waitcnt lgkmcnt(10)
    v_mfma_f32_16x16x32_bf16 v[8:11], v[88:91], v[64:67], v[8:11]
    ds_read_b64_tr_b16 v[120:121], v134 offset:24576
    v_mfma_f32_16x16x32_bf16 v[24:27], v[88:91], v[68:71], v[24:27]
    ds_read_b64_tr_b16 v[122:123], v134 offset:25600
    v_mfma_f32_16x16x32_bf16 v[40:43], v[88:91], v[72:75], v[40:43]
    ds_read_b64_tr_b16 v[124:125], v135 offset:24576
    v_mfma_f32_16x16x32_bf16 v[56:59], v[88:91], v[76:79], v[56:59]
    ds_read_b64_tr_b16 v[126:127], v135 offset:25600
    s_waitcnt lgkmcnt(12)
    v_mfma_f32_16x16x32_bf16 v[12:15], v[92:95], v[64:67], v[12:15]
    v_mfma_f32_16x16x32_bf16 v[28:31], v[92:95], v[68:71], v[28:31]
    s_add_u32 s40, s40, 1
    v_mfma_f32_16x16x32_bf16 v[44:47], v[92:95], v[72:75], v[44:47]
    s_cmp_eq_u32 s40, 28
    v_mfma_f32_16x16x32_bf16 v[60:63], v[92:95], v[76:79], v[60:63]
    s_cbranch_scc1 G2_tail
    s_waitcnt lgkmcnt(6)
    v_mfma_f32_16x16x32_bf16 v[0:3], v[112:115], v[96:99], v[0:3]
    v_mfma_f32_16x16x32_bf16 v[16:19], v[112:115], v[100:103], v[16:19]
    s_waitcnt lgkmcnt(0)
    s_barrier
    v_mfma_f32_16x16x32_bf16 v[32:35], v[112:115], v[104:107], v[32:35]
    ds_read_b128 v[64:67], v128 offset:32768
    v_mfma_f32_16x16x32_bf16 v[48:51], v[112:115], v[108:111], v[48:51]
    ds_read_b128 v[68:71], v128 offset:34816
    v_mfma_f32_16x16x32_bf16 v[4:7], v[116:119], v[96:99], v[4:7]
    ds_read_b128 v[72:75], v130 offset:32768
    v_mfma_f32_16x16x32_bf16 v[20:23], v[116:119], v[100:103], v[20:23]
    ds_read_b128 v[76:79], v130 offset:34816
    v_mfma_f32_16x16x32_bf16 v[36:39], v[116:119], v[104:107], v[36:39]
    ds_read_b64_tr_b16 v[80:81], v132 offset:32768
    v_mfma_f32_16x16x32_bf16 v[52:55], v[116:119], v[108:111], v[52:55]
    ds_read_b64_tr_b16 v[82:83], v132 offset:33792
    v_mfma_f32_16x16x32_bf16 v[8:11], v[120:123], v[96:99], v[8:11]
    ds_read_b64_tr_b16 v[84:85], v133 offset:32768
    v_mfma_f32_16x16x32_bf16 v[24:27], v[120:123], v[100:103], v[24:27]
    ds_read_b64_tr_b16 v[86:87], v133 offset:33792
    v_mfma_f32_16x16x32_bf16 v[40:43], v[120:123], v[104:107], v[40:43]
    ds_read_b64_tr_b16 v[88:89], v134 offset:32768
    v_mfma_f32_16x16x32_bf16 v[56:59], v[120:123], v[108:111], v[56:59]
    ds_read_b64_tr_b16 v[90:91], v134 offset:33792
    v_mfma_f32_16x16x32_bf16 v[12:15], v[124:127], v[96:99], v[12:15]
    ds_read_b64_tr_b16 v[92:93], v135 offset:32768
    v_mfma_f32_16x16x32_bf16 v[28:31], v[124:127], v[100:103], v[28:31]
    ds_read_b64_tr_b16 v[94:95], v135 offset:33792
    v_mfma_f32_16x16x32_bf16 v[44:47], v[124:127], v[104:107], v[44:47]
    v_mfma_f32_16x16x32_bf16 v[60:63], v[124:127], v[108:111], v[60:63]
G2_s2:
    s_waitcnt lgkmcnt(6)
    v_mfma_f32_16x16x32_bf16 v[0:3], v[80:83], v[64:67], v[0:3]
    ds_read_b128 v[96:99], v129 offset:32768
    v_mfma_f32_16x16x32_bf16 v[16:19], v[80:83], v[68:71], v[16:19]
    ds_read_b128 v[100:103], v129 offset:34816
    v_mfma_f32_16x16x32_bf16 v[32:35], v[80:83], v[72:75], v[32:35]
    ds_read_b128 v[104:107], v131 offset:32768
    v_mfma_f32_16x16x32_bf16 v[48:51], v[80:83], v[76:79], v[48:51]
    ds_read_b128 v[108:111], v131 offset:34816
    s_waitcnt lgkmcnt(8)
    v_mfma_f32_16x16x32_bf16 v[4:7], v[84:87], v[64:67], v[4:7]
    ds_read_b64_tr_b16 v[112:113], v132 offset:40960
    v_mfma_f32_16x16x32_bf16 v[20:23], v[84:87], v[68:71], v[20:23]
    ds_read_b64_tr_b16 v[114:115], v132 offset:41984
    v_mfma_f32_16x16x32_bf16 v[36:39], v[84:87], v[72:75], v[36:39]
    ds_read_b64_tr_b16 v[116:117], v133 offset:40960
    v_mfma_f32_16x16x32_bf16 v[52:55], v[84:87], v[76:79], v[52:55]
    ds_read_b64_tr_b16 v[118:119], v133 offset:41984
    s_waitcnt lgkmcnt(10)
    v_mfma_f32_16x16x32_bf16 v[8:11], v[88:91], v[64:67], v[8:11]
    ds_read_b64_tr_b16 v[120:121], v134 offset:40960
    v_mfma_f32_16x16x32_bf16 v[24:27], v[88:91], v[68:71], v[24:27]
    ds_read_b64_tr_b16 v[122:123], v134 offset:41984
    v_mfma_f32_16x16x32_bf16 v[40:43], v[88:91], v[72:75], v[40:43]
    ds_read_b64_tr_b16 v[124:125], v135 offset:40960
    v_mfma_f32_16x16x32_bf16 v[56:59], v[88:91], v[76:79], v[56:59]
    ds_read_b64_tr_b16 v[126:127], v135 offset:41984
    s_waitcnt lgkmcnt(12)
    v_mfma_f32_16x16x32_bf16 v[12:15], v[92:95], v[64:67], v[12:15]
    v_mfma_f32_16x16x32_bf16 v[28:31], v[92:95], v[68:71], v[28:31]
    s_add_u32 s40, s40, 1
    v_mfma_f32_16x16x32_bf16 v[44:47], v[92:95], v[72:75], v[44:47]
    s_cmp_eq_u32 s40, 28
    v_mfma_f32_16x16x32_bf16 v[60:63], v[92:95], v[76:79], v[60:63]
    s_cbranch_scc1 G2_tail
    s_waitcnt lgkmcnt(6)
    v_mfma_f32_16x16x32_bf16 v[0:3], v[112:115], v[96:99], v[0:3]
    v_mfma_f32_16x16x32_bf16 v[16:19], v[112:115], v[100:103], v[16:19]
    s_waitcnt lgkmcnt(0)
    s_barrier
    v_mfma_f32_16x16x32_bf16 v[32:35], v[112:115], v[104:107], v[32:35]
    ds_read_b128 v[64:67], v128 offset:49152
    v_mfma_f32_16x16x32_bf16 v[48:51], v[112:115], v[108:111], v[48:51]
    ds_read_b128 v[68:71], v128 offset:51200
    v_mfma_f32_16x16x32_bf16 v[4:7], v[116:119], v[96:99], v[4:7]
    ds_read_b128 v[72:75], v130 offset:49152
    v_mfma_f32_16x16x32_bf16 v[20:23], v[116:119], v[100:103], v[20:23]
    ds_read_b128 v[76:79], v130 offset:51200
    v_mfma_f32_16x16x32_bf16 v[36:39], v[116:119], v[104:107], v[36:39]
    ds_read_b64_tr_b16 v[80:81], v132 offset:49152
    v_mfma_f32_16x16x32_bf16 v[52:55], v[116:119], v[108:111], v[52:55]
    ds_read_b64_tr_b16 v[82:83], v132 offset:50176
    v_mfma_f32_16x16x32_bf16 v[8:11], v[120:123], v[96:99], v[8:11]
    ds_read_b64_tr_b16 v[84:85], v133 offset:49152
    v_mfma_f32_16x16x32_bf16 v[24:27], v[120:123], v[100:103], v[24:27]
    ds_read_b64_tr_b16 v[86:87], v133 offset:50176
    v_mfma_f32_16x16x32_bf16 v[40:43], v[120:123], v[104:107], v[40:43]
    ds_read_b64_tr_b16 v[88:89], v134 offset:49152
    v_mfma_f32_16x16x32_bf16 v[56:59], v[120:123], v[108:111], v[56:59]
    ds_read_b64_tr_b16 v[90:91], v134 offset:50176
    v_mfma_f32_16x16x32_bf16 v[12:15], v[124:127], v[96:99], v[12:15]
    ds_read_b64_tr_b16 v[92:93], v135 offset:49152
    v_mfma_f32_16x16x32_bf16 v[28:31], v[124:127], v[100:103], v[28:31]
    ds_read_b64_tr_b16 v[94:95], v135 offset:50176
    v_mfma_f32_16x16x32_bf16 v[44:47], v[124:127], v[104:107], v[44:47]
    v_mfma_f32_16x16x32_bf16 v[60:63], v[124:127], v[108:111], v[60:63]
G2_s3:
    s_waitcnt lgkmcnt(6)
    v_mfma_f32_16x16x32_bf16 v[0:3], v[80:83], v[64:67], v[0:3]
    ds_read_b128 v[96:99], v129 offset:49152
    v_mfma_f32_16x16x32_bf16 v[16:19], v[80:83], v[68:71], v[16:19]
    ds_read_b128 v[100:103], v129 offset:51200
    v_mfma_f32_16x16x32_bf16 v[32:35], v[80:83], v[72:75], v[32:35]
    ds_read_b128 v[104:107], v131 offset:49152
    v_mfma_f32_16x16x32_bf16 v[48:51], v[80:83], v[76:79], v[48:51]
    ds_read_b128 v[108:111], v131 offset:51200
    s_waitcnt lgkmcnt(8)
    v_mfma_f32_16x16x32_bf16 v[4:7], v[84:87], v[64:67], v[4:7]
    ds_read_b64_tr_b16 v[112:113], v132 offset:57344
    v_mfma_f32_16x16x32_bf16 v[20:23], v[84:87], v[68:71], v[20:23]
    ds_read_b64_tr_b16 v[114:115], v132 offset:58368
    v_mfma_f32_16x16x32_bf16 v[36:39], v[84:87], v[72:75], v[36:39]
    ds_read_b64_tr_b16 v[116:117], v133 offset:57344
    v_mfma_f32_16x16x32_bf16 v[52:55], v[84:87], v[76:79], v[52:55]
    ds_read_b64_tr_b16 v[118:119], v133 offset:58368
    s_waitcnt lgkmcnt(10)
    v_mfma_f32_16x16x32_bf16 v[8:11], v[88:91], v[64:67], v[8:11]
    ds_read_b64_tr_b16 v[120:121], v134 offset:57344
    v_mfma_f32_16x16x32_bf16 v[24:27], v[88:91], v[68:71], v[24:27]
    ds_read_b64_tr_b16 v[122:123], v134 offset:58368
    v_mfma_f32_16x16x32_bf16 v[40:43], v[88:91], v[72:75], v[40:43]
    ds_read_b64_tr_b16 v[124:125], v135 offset:57344
    v_mfma_f32_16x16x32_bf16 v[56:59], v[88:91], v[76:79], v[56:59]
    ds_read_b64_tr_b16 v[126:127], v135 offset:58368
    s_waitcnt lgkmcnt(12)
    v_mfma_f32_16x16x32_bf16 v[12:15], v[92:95], v[64:67], v[12:15]
    v_mfma_f32_16x16x32_bf16 v[28:31], v[92:95], v[68:71], v[28:31]
    s_add_u32 s40, s40, 1
    v_mfma_f32_16x16x32_bf16 v[44:47], v[92:95], v[72:75], v[44:47]
    s_cmp_eq_u32 s40, 28
    v_mfma_f32_16x16x32_bf16 v[60:63], v[92:95], v[76:79], v[60:63]
    s_cbranch_scc1 G2_tail
    s_waitcnt lgkmcnt(6)
    v_mfma_f32_16x16x32_bf16 v[0:3], v[112:115], v[96:99], v[0:3]
    v_mfma_f32_16x16x32_bf16 v[16:19], v[112:115], v[100:103], v[16:19]
    s_waitcnt lgkmcnt(0)
    s_barrier
    v_mfma_f32_16x16x32_bf16 v[32:35], v[112:115], v[104:107], v[32:35]
    ds_read_b128 v[64:67], v128 offset:0
    v_mfma_f32_16x16x32_bf16 v[48:51], v[112:115], v[108:111], v[48:51]
    ds_read_b128 v[68:71], v128 offset:2048
    v_mfma_f32_16x16x32_bf16 v[4:7], v[116:119], v[96:99], v[4:7]
    ds_read_b128 v[72:75], v130 offset:0
    v_mfma_f32_16x16x32_bf16 v[20:23], v[116:119], v[100:103], v[20:23]
    ds_read_b128 v[76:79], v130 offset:2048
    v_mfma_f32_16x16x32_bf16 v[36:39], v[116:119], v[104:107], v[36:39]
    ds_read_b64_tr_b16 v[80:81], v132 offset:0
    v_mfma_f32_16x16x32_bf16 v[52:55], v[116:119], v[108:111], v[52:55]
    ds_read_b64_tr_b16 v[82:83], v132 offset:1024
    v_mfma_f32_16x16x32_bf16 v[8:11], v[120:123], v[96:99], v[8:11]
    ds_read_b64_tr_b16 v[84:85], v133 offset:0
    v_mfma_f32_16x16x32_bf16 v[24:27], v[120:123], v[100:103], v[24:27]
    ds_read_b64_tr_b16 v[86:87], v133 offset:1024
    v_mfma_f32_16x16x32_bf16 v[40:43], v[120:123], v[104:107], v[40:43]
    ds_read_b64_tr_b16 v[88:89], v134 offset:0
    v_mfma_f32_16x16x32_bf16 v[56:59], v[120:123], v[108:111], v[56:59]
    ds_read_b64_tr_b16 v[90:91], v134 offset:1024
    v_mfma_f32_16x16x32_bf16 v[12:15], v[124:127], v[96:99], v[12:15]
    ds_read_b64_tr_b16 v[92:93], v135 offset:0
    v_mfma_f32_16x16x32_bf16 v[28:31], v[124:127], v[100:103], v[28:31]
    ds_read_b64_tr_b16 v[94:95], v135 offset:1024
    v_mfma_f32_16x16x32_bf16 v[44:47], v[124:127], v[104:107], v[44:47]
    v_mfma_f32_16x16x32_bf16 v[60:63], v[124:127], v[108:111], v[60:63]
    s_branch G2_s0
G2_tail:
    s_waitcnt lgkmcnt(0)
    s_barrier
    v_mfma_f32_16x16x32_bf16 v[32:35], v[112:115], v[104:107], v[32:35]
    v_mfma_f32_16x16x32_bf16 v[48:51], v[112:115], v[108:111], v[48:51]
    v_mfma_f32_16x16x32_bf16 v[36:39], v[116:119], v[104:107], v[36:39]
    v_mfma_f32_16x16x32_bf16 v[52:55], v[116:119], v[108:111], v[52:55]
    v_mfma_f32_16x16x32_bf16 v[40:43], v[120:123], v[104:107], v[40:43]
    v_mfma_f32_16x16x32_bf16 v[56:59], v[120:123], v[108:111], v[56:59]
    v_mfma_f32_16x16x32_bf16 v[44:47], v[124:127], v[104:107], v[44:47]
    v_mfma_f32_16x16x32_bf16 v[60:63], v[124:127], v[108:111], v[60:63]
    s_add_u32 s12, s4, 0x2000000
    s_addc_u32 s13, s5, 0
    s_mov_b32 s14, 0x400000
    s_mov_b32 s15, 0x00020000
    v_mfma_f32_16x16x32_bf16 v[0:3], v[112:115], v[96:99], v[0:3]
    v_lshlrev_b32 v203, 4, v240
    s_lshl_b32 s36, s2, 14
    s_lshl_b32 s37, s33, 12
    s_add_u32 s36, s36, s37
    s_xor_b32 s45, s36, 0x10000
    v_mfma_f32_16x16x32_bf16 v[16:19], v[112:115], v[100:103], v[16:19]
    v_cvt_pk_bf16_f32 v64, v32, v33
    v_cvt_pk_bf16_f32 v65, v34, v35
    v_cvt_pk_bf16_f32 v66, v36, v37
    v_cvt_pk_bf16_f32 v67, v38, v39
    buffer_store_dwordx4 v[64:67], v203, s[12:15], s36 offen offset:0 sc1
    v_mfma_f32_16x16x32_bf16 v[4:7], v[116:119], v[96:99], v[4:7]
    v_mfma_f32_16x16x32_bf16 v[20:23], v[116:119], v[100:103], v[20:23]
    v_cvt_pk_bf16_f32 v68, v40, v41
    v_cvt_pk_bf16_f32 v69, v42, v43
    v_cvt_pk_bf16_f32 v70, v44, v45
    v_cvt_pk_bf16_f32 v71, v46, v47
    buffer_store_dwordx4 v[68:71], v203, s[12:15], s36 offen offset:1024 sc1
    v_mfma_f32_16x16x32_bf16 v[8:11], v[120:123], v[96:99], v[8:11]
    v_mfma_f32_16x16x32_bf16 v[24:27], v[120:123], v[100:103], v[24:27]
    v_cvt_pk_bf16_f32 v72, v48, v49
    v_cvt_pk_bf16_f32 v73, v50, v51
    v_cvt_pk_bf16_f32 v74, v52, v53
    v_cvt_pk_bf16_f32 v75, v54, v55
    buffer_store_dwordx4 v[72:75], v203, s[12:15], s36 offen offset:2048 sc1
    v_mfma_f32_16x16x32_bf16 v[12:15], v[124:127], v[96:99], v[12:15]
    v_mfma_f32_16x16x32_bf16 v[28:31], v[124:127], v[100:103], v[28:31]
    v_cvt_pk_bf16_f32 v76, v56, v57
    v_cvt_pk_bf16_f32 v77, v58, v59
    v_cvt_pk_bf16_f32 v78, v60, v61
    v_cvt_pk_bf16_f32 v79, v62, v63
    buffer_store_dwordx4 v[76:79], v203, s[12:15], s36 offen offset:3072 sc1
    s_add_u32 s60, s4, 0x2800000
    s_addc_u32 s61, s5, 0
    s_mov_b32 s62, 0x23000
    s_mov_b32 s63, 0x00020000
    s_lshl_b32 s43, s26, 7
    s_lshl_b32 s44, s54, 5
    s_add_u32 s43, s43, s44
    s_lshl_b32 s44, s33, 2
    s_add_u32 s43, s43, s44
    s_lshl_b32 s43, s43, 11
    s_lshl_b32 s44, s55, 8
    s_add_u32 s43, s43, s44
    s_add_u32 s44, s43, 131072
    v_bfe_u32 v206, v240, 2, 2
    v_lshl_add_u32 v206, v242, 2, v206
    v_bfe_u32 v207, v206, 1, 2
    s_lshl_b32 s38, s34, 1
    v_xor_b32 v207, s38, v207
    v_lshlrev_b32 v207, 5, v207
    v_lshl_add_u32 v207, v206, 7, v207
    v_and_b32 v208, 3, v240
    v_lshl_add_u32 v207, v208, 3, v207
    s_lshl_b32 s38, s35, 13
    s_add_u32 s38, s38, 65536
    v_add_u32 v207, s38, v207
    v_xor_b32 v208, 32, v207
    ds_read_b64_tr_b16 v[140:141], v207 offset:0
    ds_read_b64_tr_b16 v[142:143], v207 offset:2048
    ds_read_b64_tr_b16 v[144:145], v207 offset:4096
    ds_read_b64_tr_b16 v[146:147], v207 offset:6144
    ds_read_b64_tr_b16 v[148:149], v208 offset:0
    ds_read_b64_tr_b16 v[150:151], v208 offset:2048
    ds_read_b64_tr_b16 v[152:153], v208 offset:4096
    ds_read_b64_tr_b16 v[154:155], v208 offset:6144
    s_lshl_b32 s38, s34, 8
    s_lshl_b32 s39, s54, 7
    s_add_u32 s38, s38, s39
    s_add_u32 s38, s38, 147712
    v_lshl_add_u32 v206, v241, 2, s38
    ds_read_b32 v192, v206
    ds_read_b32 v194, v206 offset:64
    s_lshl_b32 s36, s2, 9
    s_lshl_b32 s37, s33, 7
    s_add_u32 s36, s36, s37
    s_xor_b32 s37, s36, 0x800
    v_mov_b32 v209, 1
    v_mov_b32 v210, 0
    v_lshrrev_b32 v206, 1, v242
    v_xor_b32 v206, v206, v241
    s_lshl_b32 s38, s34, 13
    v_lshl_add_u32 v207, v241, 8, s38
    v_and_b32 v208, 1, v242
    v_lshl_add_u32 v207, v208, 3, v207
    s_lshl_b32 s39, s35, 3
    s_add_u32 s38, s39, 0
    v_xor_b32 v208, s38, v206
    v_lshl_add_u32 v132, v208, 4, v207
    s_add_u32 s38, s39, 2
    v_xor_b32 v208, s38, v206
    v_lshl_add_u32 v133, v208, 4, v207
    s_add_u32 s38, s39, 4
    v_xor_b32 v208, s38, v206
    v_lshl_add_u32 v134, v208, 4, v207
    s_add_u32 s38, s39, 6
    v_xor_b32 v208, s38, v206
    v_lshl_add_u32 v135, v208, 4, v207
    s_mov_b64 exec, 1
    s_waitcnt vmcnt(0)
    buffer_store_dword v209, v210, s[60:63], s36 offen sc1
    buffer_load_dword v211, v210, s[60:63], s37 offen sc1
    s_mov_b64 exec, -1
    s_waitcnt lgkmcnt(0)
    v_lshlrev_b32 v216, 16, v232
    v_and_b32 v217, 0xffff0000, v232
    v_lshlrev_b32 v218, 16, v233
    v_and_b32 v219, 0xffff0000, v233
    v_lshlrev_b32 v220, 16, v234
    v_and_b32 v221, 0xffff0000, v234
    v_lshlrev_b32 v222, 16, v235
    v_and_b32 v223, 0xffff0000, v235
    v_lshlrev_b32 v224, 16, v236
    v_and_b32 v225, 0xffff0000, v236
    v_lshlrev_b32 v226, 16, v237
    v_and_b32 v227, 0xffff0000, v237
    v_lshlrev_b32 v228, 16, v238
    v_and_b32 v229, 0xffff0000, v238
    v_lshlrev_b32 v230, 16, v239
    v_and_b32 v231, 0xffff0000, v239
    v_lshlrev_b32 v160, 16, v140
    v_and_b32 v161, 0xffff0000, v140
    v_lshlrev_b32 v162, 16, v141
    v_and_b32 v163, 0xffff0000, v141
    v_pk_add_f32 v[160:161], v[160:161], v[216:217]
    v_pk_add_f32 v[162:163], v[162:163], v[218:219]
    v_lshlrev_b32 v164, 16, v142
    v_and_b32 v165, 0xffff0000, v142
    v_lshlrev_b32 v166, 16, v143
    v_and_b32 v167, 0xffff0000, v143
    v_pk_add_f32 v[164:165], v[164:165], v[220:221]
    v_pk_add_f32 v[166:167], v[166:167], v[222:223]
    v_lshlrev_b32 v168, 16, v144
    v_and_b32 v169, 0xffff0000, v144
    v_lshlrev_b32 v170, 16, v145
    v_and_b32 v171, 0xffff0000, v145
    v_pk_add_f32 v[168:169], v[168:169], v[224:225]
    v_pk_add_f32 v[170:171], v[170:171], v[226:227]
    v_lshlrev_b32 v172, 16, v146
    v_and_b32 v173, 0xffff0000, v146
    v_lshlrev_b32 v174, 16, v147
    v_and_b32 v175, 0xffff0000, v147
    v_pk_add_f32 v[172:173], v[172:173], v[228:229]
    v_pk_add_f32 v[174:175], v[174:175], v[230:231]
    v_lshlrev_b32 v176, 16, v148
    v_and_b32 v177, 0xffff0000, v148
    v_lshlrev_b32 v178, 16, v149
    v_and_b32 v179, 0xffff0000, v149
    v_pk_add_f32 v[176:177], v[176:177], v[216:217]
    v_pk_add_f32 v[178:179], v[178:179], v[218:219]
    v_lshlrev_b32 v180, 16, v150
    v_and_b32 v181, 0xffff0000, v150
    v_lshlrev_b32 v182, 16, v151
    v_and_b32 v183, 0xffff0000, v151
    v_pk_add_f32 v[180:181], v[180:181], v[220:221]
    v_pk_add_f32 v[182:183], v[182:183], v[222:223]
    v_lshlrev_b32 v184, 16, v152
    v_and_b32 v185, 0xffff0000, v152
    v_lshlrev_b32 v186, 16, v153
    v_and_b32 v187, 0xffff0000, v153
    v_pk_add_f32 v[184:185], v[184:185], v[224:225]
    v_pk_add_f32 v[186:187], v[186:187], v[226:227]
    v_lshlrev_b32 v188, 16, v154
    v_and_b32 v189, 0xffff0000, v154
    v_lshlrev_b32 v190, 16, v155
    v_and_b32 v191, 0xffff0000, v155
    v_pk_add_f32 v[188:189], v[188:189], v[228:229]
    v_pk_add_f32 v[190:191], v[190:191], v[230:231]
    s_mov_b64 exec, 1
G_poll:
    s_waitcnt vmcnt(0)
    v_readfirstlane_b32 s38, v211
    s_cmp_eq_u32 s38, 1
    s_cbranch_scc1 G_seen
    buffer_load_dword v211, v210, s[60:63], s37 offen sc1
    s_branch G_poll
G_seen:
    s_mov_b64 exec, -1
    buffer_load_dwordx4 v[96:99], v203, s[12:15], s45 offen offset:0 sc1
    buffer_load_dwordx4 v[100:103], v203, s[12:15], s45 offen offset:1024 sc1
    buffer_load_dwordx4 v[104:107], v203, s[12:15], s45 offen offset:2048 sc1
    buffer_load_dwordx4 v[108:111], v203, s[12:15], s45 offen offset:3072 sc1
    s_waitcnt vmcnt(3)
    v_lshlrev_b32 v212, 16, v96
    v_and_b32 v213, 0xffff0000, v96
    v_lshlrev_b32 v214, 16, v97
    v_and_b32 v215, 0xffff0000, v97
    v_pk_add_f32 v[0:1], v[0:1], v[212:213]
    v_pk_add_f32 v[2:3], v[2:3], v[214:215]
    v_pk_fma_f32 v[0:1], v[0:1], v[192:193], v[160:161] op_sel_hi:[1,0,1]
    v_pk_fma_f32 v[2:3], v[2:3], v[192:193], v[162:163] op_sel_hi:[1,0,1]
    v_cvt_pk_bf16_f32 v0, v0, v1
    v_cvt_pk_bf16_f32 v1, v2, v3
    ds_write_b64 v132, v[0:1] offset:0
    v_lshlrev_b32 v212, 16, v98
    v_and_b32 v213, 0xffff0000, v98
    v_lshlrev_b32 v214, 16, v99
    v_and_b32 v215, 0xffff0000, v99
    v_pk_add_f32 v[4:5], v[4:5], v[212:213]
    v_pk_add_f32 v[6:7], v[6:7], v[214:215]
    v_pk_fma_f32 v[4:5], v[4:5], v[192:193], v[164:165] op_sel_hi:[1,0,1]
    v_pk_fma_f32 v[6:7], v[6:7], v[192:193], v[166:167] op_sel_hi:[1,0,1]
    v_cvt_pk_bf16_f32 v4, v4, v5
    v_cvt_pk_bf16_f32 v5, v6, v7
    ds_write_b64 v133, v[4:5] offset:0
    s_waitcnt vmcnt(2)
    v_lshlrev_b32 v212, 16, v100
    v_and_b32 v213, 0xffff0000, v100
    v_lshlrev_b32 v214, 16, v101
    v_and_b32 v215, 0xffff0000, v101
    v_pk_add_f32 v[8:9], v[8:9], v[212:213]
    v_pk_add_f32 v[10:11], v[10:11], v[214:215]
    v_pk_fma_f32 v[8:9], v[8:9], v[192:193], v[168:169] op_sel_hi:[1,0,1]
    v_pk_fma_f32 v[10:11], v[10:11], v[192:193], v[170:171] op_sel_hi:[1,0,1]
    v_cvt_pk_bf16_f32 v8, v8, v9
    v_cvt_pk_bf16_f32 v9, v10, v11
    ds_write_b64 v134, v[8:9] offset:0
    v_lshlrev_b32 v212, 16, v102
    v_and_b32 v213, 0xffff0000, v102
    v_lshlrev_b32 v214, 16, v103
    v_and_b32 v215, 0xffff0000, v103
    v_pk_add_f32 v[12:13], v[12:13], v[212:213]
    v_pk_add_f32 v[14:15], v[14:15], v[214:215]
    v_pk_fma_f32 v[12:13], v[12:13], v[192:193], v[172:173] op_sel_hi:[1,0,1]
    v_pk_fma_f32 v[14:15], v[14:15], v[192:193], v[174:175] op_sel_hi:[1,0,1]
    v_cvt_pk_bf16_f32 v12, v12, v13
    v_cvt_pk_bf16_f32 v13, v14, v15
    ds_write_b64 v135, v[12:13] offset:0
    s_waitcnt vmcnt(1)
    v_lshlrev_b32 v212, 16, v104
    v_and_b32 v213, 0xffff0000, v104
    v_lshlrev_b32 v214, 16, v105
    v_and_b32 v215, 0xffff0000, v105
    v_pk_add_f32 v[16:17], v[16:17], v[212:213]
    v_pk_add_f32 v[18:19], v[18:19], v[214:215]
    v_pk_fma_f32 v[16:17], v[16:17], v[194:195], v[176:177] op_sel_hi:[1,0,1]
    v_pk_fma_f32 v[18:19], v[18:19], v[194:195], v[178:179] op_sel_hi:[1,0,1]
    v_cvt_pk_bf16_f32 v16, v16, v17
    v_cvt_pk_bf16_f32 v17, v18, v19
    ds_write_b64 v132, v[16:17] offset:4096
    v_lshlrev_b32 v212, 16, v106
    v_and_b32 v213, 0xffff0000, v106
    v_lshlrev_b32 v214, 16, v107
    v_and_b32 v215, 0xffff0000, v107
    v_pk_add_f32 v[20:21], v[20:21], v[212:213]
    v_pk_add_f32 v[22:23], v[22:23], v[214:215]
    v_pk_fma_f32 v[20:21], v[20:21], v[194:195], v[180:181] op_sel_hi:[1,0,1]
    v_pk_fma_f32 v[22:23], v[22:23], v[194:195], v[182:183] op_sel_hi:[1,0,1]
    v_cvt_pk_bf16_f32 v20, v20, v21
    v_cvt_pk_bf16_f32 v21, v22, v23
    ds_write_b64 v133, v[20:21] offset:4096
    s_waitcnt vmcnt(0)
    v_lshlrev_b32 v212, 16, v108
    v_and_b32 v213, 0xffff0000, v108
    v_lshlrev_b32 v214, 16, v109
    v_and_b32 v215, 0xffff0000, v109
    v_pk_add_f32 v[24:25], v[24:25], v[212:213]
    v_pk_add_f32 v[26:27], v[26:27], v[214:215]
    v_pk_fma_f32 v[24:25], v[24:25], v[194:195], v[184:185] op_sel_hi:[1,0,1]
    v_pk_fma_f32 v[26:27], v[26:27], v[194:195], v[186:187] op_sel_hi:[1,0,1]
    v_cvt_pk_bf16_f32 v24, v24, v25
    v_cvt_pk_bf16_f32 v25, v26, v27
    ds_write_b64 v134, v[24:25] offset:4096
    v_lshlrev_b32 v212, 16, v110
    v_and_b32 v213, 0xffff0000, v110
    v_lshlrev_b32 v214, 16, v111
    v_and_b32 v215, 0xffff0000, v111
    v_pk_add_f32 v[28:29], v[28:29], v[212:213]
    v_pk_add_f32 v[30:31], v[30:31], v[214:215]
    v_pk_fma_f32 v[28:29], v[28:29], v[194:195], v[188:189] op_sel_hi:[1,0,1]
    v_pk_fma_f32 v[30:31], v[30:31], v[194:195], v[190:191] op_sel_hi:[1,0,1]
    v_cvt_pk_bf16_f32 v28, v28, v29
    v_cvt_pk_bf16_f32 v29, v30, v31
    ds_write_b64 v135, v[28:29] offset:4096
    s_waitcnt lgkmcnt(0)
G_epi2:
    v_mbcnt_lo_u32_b32 v2, -1, 0
    v_mbcnt_hi_u32_b32 v2, -1, v2
    v_lshrrev_b32 v3, 4, v2
    v_and_b32 v5, 15, v2
    v_lshlrev_b32 v6, 11, v3
    v_lshl_add_u32 v6, v5, 4, v6
    s_lshl_b32 s36, s33, 2
    v_add_u32 v3, s36, v3
    v_xor_b32 v4, v3, v2
    v_and_b32 v4, 15, v4
    v_lshlrev_b32 v4, 4, v4
    v_lshl_add_u32 v3, v3, 8, v4
    s_mov_b32 s12, s52
    s_mov_b32 s13, s53
    s_mov_b32 s14, 0x400000
    s_mov_b32 s15, 0x00020000
    s_barrier
    ds_read_b128 v[16:19], v3
    ds_read_b128 v[20:23], v3 offset:8192
    s_waitcnt lgkmcnt(1)
    buffer_store_dwordx4 v[16:19], v6, s[12:15], s43 offen
    s_waitcnt lgkmcnt(0)
    buffer_store_dwordx4 v[20:23], v6, s[12:15], s44 offen
F_end:
    s_endpgm
G_xa0:
    s_cmp_eq_u32 s35, 0
    s_cbranch_scc0 G_x1a0
    v_mfma_f32_16x16x32_bf16 v[212:215], v[112:115], v[112:115], 0
    v_mfma_f32_16x16x32_bf16 v[216:219], v[116:119], v[116:119], 0
    v_mfma_f32_16x16x32_bf16 v[220:223], v[120:123], v[120:123], 0
    v_mfma_f32_16x16x32_bf16 v[224:227], v[124:127], v[124:127], 0
    s_branch G_x2a0
G_x1a0:
    v_mfma_f32_16x16x32_bf16 v[212:215], v[228:231], v[112:115], 0
    v_mfma_f32_16x16x32_bf16 v[216:219], v[228:231], v[116:119], 0
    v_mfma_f32_16x16x32_bf16 v[220:223], v[228:231], v[120:123], 0
    v_mfma_f32_16x16x32_bf16 v[224:227], v[228:231], v[124:127], 0
G_x2a0:
    s_branch G_xar0
G_xa1:
    s_cmp_eq_u32 s35, 0
    s_cbranch_scc0 G_x1a1
    v_mfma_f32_16x16x32_bf16 v[212:215], v[112:115], v[112:115], 0
    v_mfma_f32_16x16x32_bf16 v[216:219], v[116:119], v[116:119], 0
    v_mfma_f32_16x16x32_bf16 v[220:223], v[120:123], v[120:123], 0
    v_mfma_f32_16x16x32_bf16 v[224:227], v[124:127], v[124:127], 0
    s_branch G_x2a1
G_x1a1:
    v_mfma_f32_16x16x32_bf16 v[212:215], v[228:231], v[112:115], 0
    v_mfma_f32_16x16x32_bf16 v[216:219], v[228:231], v[116:119], 0
    v_mfma_f32_16x16x32_bf16 v[220:223], v[228:231], v[120:123], 0
    v_mfma_f32_16x16x32_bf16 v[224:227], v[228:231], v[124:127], 0
G_x2a1:
    s_branch G_xar1
G_xa2:
    s_cmp_eq_u32 s35, 0
    s_cbranch_scc0 G_x1a2
    v_mfma_f32_16x16x32_bf16 v[212:215], v[112:115], v[112:115], 0
    v_mfma_f32_16x16x32_bf16 v[216:219], v[116:119], v[116:119], 0
    v_mfma_f32_16x16x32_bf16 v[220:223], v[120:123], v[120:123], 0
    v_mfma_f32_16x16x32_bf16 v[224:227], v[124:127], v[124:127], 0
    s_branch G_x2a2
G_x1a2:
    v_mfma_f32_16x16x32_bf16 v[212:215], v[228:231], v[112:115], 0
    v_mfma_f32_16x16x32_bf16 v[216:219], v[228:231], v[116:119], 0
    v_mfma_f32_16x16x32_bf16 v[220:223], v[228:231], v[120:123], 0
    v_mfma_f32_16x16x32_bf16 v[224:227], v[228:231], v[124:127], 0
G_x2a2:
    s_branch G_xar2
G_xb:
    s_cmp_eq_u32 s35, 0
    s_cbranch_scc0 G_x1b
    v_mfma_f32_16x16x32_bf16 v[212:215], v[156:159], v[156:159], v[212:215]
    v_mfma_f32_16x16x32_bf16 v[216:219], v[160:163], v[160:163], v[216:219]
    v_mfma_f32_16x16x32_bf16 v[220:223], v[164:167], v[164:167], v[220:223]
    v_mfma_f32_16x16x32_bf16 v[224:227], v[168:171], v[168:171], v[224:227]
    s_branch G_x2b
G_x1b:
    v_mfma_f32_16x16x32_bf16 v[212:215], v[228:231], v[156:159], v[212:215]
    v_mfma_f32_16x16x32_bf16 v[216:219], v[228:231], v[160:163], v[216:219]
    v_mfma_f32_16x16x32_bf16 v[220:223], v[228:231], v[164:167], v[220:223]
    v_mfma_f32_16x16x32_bf16 v[224:227], v[228:231], v[168:171], v[224:227]
G_x2b:
    s_nop 7
    v_cndmask_b32 v212, v212, v213, s[64:65]
    v_cndmask_b32 v212, v212, v214, s[66:67]
    v_cndmask_b32 v212, v212, v215, s[68:69]
    v_cndmask_b32 v212, 0, v212, s[70:71]
    v_cndmask_b32 v216, v216, v217, s[64:65]
    v_cndmask_b32 v216, v216, v218, s[66:67]
    v_cndmask_b32 v216, v216, v219, s[68:69]
    v_cndmask_b32 v216, 0, v216, s[70:71]
    v_cndmask_b32 v220, v220, v221, s[64:65]
    v_cndmask_b32 v220, v220, v222, s[66:67]
    v_cndmask_b32 v220, v220, v223, s[68:69]
    v_cndmask_b32 v220, 0, v220, s[70:71]
    v_cndmask_b32 v224, v224, v225, s[64:65]
    v_cndmask_b32 v224, v224, v226, s[66:67]
    v_cndmask_b32 v224, v224, v227, s[68:69]
    v_cndmask_b32 v224, 0, v224, s[70:71]
    v_mov_b32 v213, v212
    v_mov_b32 v217, v216
    v_mov_b32 v221, v220
    v_mov_b32 v225, v224
    v_permlane16_swap_b32 v213, v212
    v_permlane16_swap_b32 v217, v216
    v_permlane16_swap_b32 v221, v220
    v_permlane16_swap_b32 v225, v224
    v_add_f32 v212, v212, v213
    v_add_f32 v216, v216, v217
    v_add_f32 v220, v220, v221
    v_add_f32 v224, v224, v225
    v_mov_b32 v213, v212
    v_mov_b32 v217, v216
    v_mov_b32 v221, v220
    v_mov_b32 v225, v224
    v_permlane32_swap_b32 v213, v212
    v_permlane32_swap_b32 v217, v216
    v_permlane32_swap_b32 v221, v220
    v_permlane32_swap_b32 v225, v224
    v_add_f32 v212, v212, v213
    v_add_f32 v216, v216, v217
    v_add_f32 v220, v220, v221
    v_add_f32 v224, v224, v225
    v_cmp_eq_u32 vcc, 1, v242
    v_cmp_eq_u32 s[64:65], 2, v242
    v_cmp_eq_u32 s[66:67], 3, v242
    v_cndmask_b32 v212, v212, v216, vcc
    v_cndmask_b32 v212, v212, v220, s[64:65]
    v_cndmask_b32 v212, v212, v224, s[66:67]
    v_lshlrev_b32 v213, 2, v240
    v_min_u32 v212, -2, v212
    buffer_store_dword v212, v213, s[72:75], s59 offen sc1
    s_cmp_eq_u32 s40, 2
    s_cbranch_scc1 G1_s2
    s_cmp_eq_u32 s40, 3
    s_cbranch_scc1 G1_s0
    s_branch G1_s1
G_retry2:
    buffer_load_dword v9, v8, s[60:63], s46 offen offset:32 sc1
    s_waitcnt vmcnt(0)
    s_branch G_chk2
G_retry:
    s_sleep 2
    buffer_load_dword v32, v206, s[20:23], s41 offen offset:0 sc1
    buffer_load_dword v33, v206, s[20:23], s41 offen offset:512 sc1
    buffer_load_dword v34, v206, s[20:23], s41 offen offset:1024 sc1
    buffer_load_dword v35, v206, s[20:23], s41 offen offset:1536 sc1
    buffer_load_dword v36, v206, s[20:23], s41 offen offset:2048 sc1
    buffer_load_dword v37, v206, s[20:23], s41 offen offset:2560 sc1
    buffer_load_dword v38, v206, s[20:23], s41 offen offset:3072 sc1
    buffer_load_dword v39, v206, s[20:23], s41 offen offset:3584 sc1
    buffer_load_dword v40, v206, s[20:23], s47 offen offset:0 sc1
    buffer_load_dword v41, v206, s[20:23], s47 offen offset:512 sc1
    buffer_load_dword v42, v206, s[20:23], s47 offen offset:1024 sc1
    buffer_load_dword v43, v206, s[20:23], s47 offen offset:1536 sc1
    buffer_load_dword v44, v206, s[20:23], s47 offen offset:2048 sc1
    buffer_load_dword v45, v206, s[20:23], s47 offen offset:2560 sc1
    buffer_load_dword v46, v206, s[20:23], s47 offen offset:3072 sc1
    buffer_load_dword v47, v206, s[20:23], s47 offen offset:3584 sc1
    s_add_u32 s36, s42, 0
    buffer_load_dwordx4 v[48:51], v207, s[20:23], s36 offen sc1
    s_add_u32 s36, s42, 57344
    buffer_load_dwordx4 v[52:55], v207, s[20:23], s36 offen sc1
    s_add_u32 s36, s42, 114688
    buffer_load_dwordx4 v[56:59], v207, s[20:23], s36 offen sc1
    s_add_u32 s36, s42, 172032
    buffer_load_dwordx4 v[60:63], v207, s[20:23], s36 offen sc1
    s_waitcnt vmcnt(0)
    s_branch G_chk
TEXT_END:
    s_endpgm
.section .rodata,"a"
.p2align 6
.amdhsa_kernel sequential_preLN__ssm_conv_h3__dense_activation_squared_relu__prompt_kernel
  .amdhsa_next_free_vgpr 256
  .amdhsa_next_free_sgpr 96
  .amdhsa_accum_offset 256
  .amdhsa_group_segment_fixed_size 0
  .amdhsa_kernarg_size 112
  .amdhsa_user_sgpr_count 2
  .amdhsa_user_sgpr_kernarg_segment_ptr 1
  .amdhsa_system_sgpr_workgroup_id_x 1
.end_amdhsa_kernel
```
